```python
import torch

def _softmax(x, axis=-1):
    return torch.softmax(x, dim=axis)
def _gelu(x):
    return torch.nn.functional.gelu(x, approximate="tanh")
def _silu(x):
    return torch.nn.functional.silu(x)
def _sigmoid(x):
    return torch.sigmoid(x)
def _layernorm(x, axis=-1, eps=1e-5):
    m = x.mean(dim=axis, keepdim=True)
    v = x.var(dim=axis, keepdim=True, unbiased=False)
    return (x - m) / torch.sqrt(v + eps)
def _scatter_add(tgt, idx, src, axis=0):
    return tgt.clone().index_add_(axis, idx, src)
def _segment_sum(src, seg, n):
    out = torch.zeros((n,) + src.shape[1:], dtype=src.dtype)
    return out.index_add_(0, seg, src)
def _pad(x, pw):
    flat = tuple(v for pair in reversed(pw) for v in pair)
    return torch.nn.functional.pad(x, flat)

kernel_name = 'interleave_layers__spectral_gfnet__sliding_block__prompt'

def setup_inputs():

    _w = (lambda a: (lambda t: t.to(torch.bfloat16) if t.is_floating_point() else t)(torch.as_tensor(a)))
    def _A_setup():
        B, S, D = 1, 2048, 512
        Df = D // 2 + 1
        return {
            "x": _w((lambda *s: torch.randn(*s, dtype=torch.bfloat16) * 0.05)(B, S, D)),
            "w_r": _w((lambda *s: torch.randn(*s, dtype=torch.bfloat16) * 1.6)(S, Df) * 0.02),
            "w_i": _w((lambda *s: torch.randn(*s, dtype=torch.bfloat16) * 1.6)(S, Df) * 0.02),
        }
    _A_in = _A_setup()

    def _B_setup():
        B, S, D = 1, 2048, 512
        return {
            "x": _w((lambda *s: torch.randn(*s, dtype=torch.bfloat16) * 0.05)(B, S, D)),
            "wqkv": _w((lambda *s: torch.randn(*s, dtype=torch.bfloat16) * 0.05)(D, 3 * D)),
            "wo": _w((lambda *s: torch.randn(*s, dtype=torch.bfloat16) * 0.05)(D, D)),
        }
    _B_in = _B_setup()

    return {
        "A_x": _A_in["x"],
        "A_w_r": _A_in["w_r"],
        "A_w_i": _A_in["w_i"],
        "B_x": _B_in["x"],
        "B_wqkv": _B_in["wqkv"],
        "B_wo": _B_in["wo"],
    }

def reference(A_x, A_w_r, A_w_i, B_x, B_wqkv, B_wo):
    def _A_ref(x, w_r, w_i):
        B, S, D = x.shape
        X = (lambda x, axes=(-2,-1): torch.fft.rfft2(x.float(), dim=axes))(x, axes=(-2, -1))
        W = w_r + 1j * w_i
        X = X * W
        y = (lambda x, s, axes=(-2,-1): torch.fft.irfft2(x, s=s, dim=axes).to(torch.bfloat16))(X, (S, D), axes=(-2, -1))
        return y

    def _B_ref(x, wqkv, wo):
        B, S, D = x.shape
        H = 32; Dh = D // H; W = 256
        qkv = (lambda x, *d: x.permute(*d))((x @ wqkv).reshape(B, S, 3, H, Dh), 2, 0, 3, 1, 4)
        q, k, v = qkv[0], qkv[1], qkv[2]
        scores = torch.einsum("bhqd,bhkd->bhqk", q, k) * (Dh ** -0.5)
        idx = torch.arange(S)
        mask = (idx[:, None] - idx[None, :] >= 0) & (idx[:, None] - idx[None, :] < W)
        scores = torch.where(mask[None, None], scores, -1e9)
        p = _softmax(scores, axis=-1)
        o = torch.einsum("bhqk,bhkd->bhqd", p, v)
        return (lambda x, *d: x.permute(*d))(o, 0, 2, 1, 3).reshape(B, S, D) @ wo

    x = A_x
    x = x + _A_ref(_layernorm(x, axis=-1), A_w_r, A_w_i)
    x = x + _B_ref(_layernorm(x, axis=-1), B_wqkv, B_wo)
    x = x + _A_ref(_layernorm(x, axis=-1), A_w_r, A_w_i)
    x = x + _B_ref(_layernorm(x, axis=-1), B_wqkv, B_wo)
    return x
```

```asm
; @launch grid=(256,1,1) block=(512,1,1) lds=163840
.amdgcn_target "amdgcn-amd-amdhsa--gfx950"
.text
.globl interleave_layers__spectral_gfnet__sliding_block__prompt_kernel
.p2align 8
.type interleave_layers__spectral_gfnet__sliding_block__prompt_kernel,@function
interleave_layers__spectral_gfnet__sliding_block__prompt_kernel:
    s_cmp_ge_u32 s2, 256
    s_cbranch_scc1 interleave_layers__spectral_gfnet__sliding_block__prompt_kernel_end
    s_load_dwordx2 s[4:5], s[0:1], 0
    s_load_dwordx4 s[40:43], s[0:1], 32
    s_load_dwordx4 s[44:47], s[0:1], 8
    s_load_dwordx2 s[36:37], s[0:1], 64
    s_load_dwordx2 s[62:63], s[0:1], 48
    s_getpc_b64 s[6:7]
pc_2:
    s_lshr_b32 s3, s2, 3
    s_lshl_b32 s3, s3, 10
    v_lshlrev_b32 v4, 6, v0
    v_add_u32 v4, s3, v4
    v_min_u32 v4, interleave_layers__spectral_gfnet__sliding_block__prompt_kernel_end-pc_2-4, v4
    v_cmp_gt_u32 vcc, 16, v0
    s_nop 0
    s_and_saveexec_b64 s[8:9], vcc
    global_load_dword v255, v4, s[6:7]
    s_mov_b64 exec, -1
    v_lshrrev_b32 v4, 6, v0
    v_and_b32 v1, 63, v0
    v_readfirstlane_b32 s24, v4
    v_and_b32 v2, 31, v0
    v_bfe_u32 v3, v0, 5, 1
    s_and_b32 s25, s24, 3
    s_lshr_b32 s26, s24, 2
    v_lshlrev_b32 v6, 4, v1
    v_and_b32 v13, 15, v1
    v_lshrrev_b32_e64 v14, 4, v1
    s_and_b32 s28, s2, 7
    s_lshl_b32 s28, s28, 3
    s_lshr_b32 s29, s2, 5
    s_add_u32 s28, s28, s29
    s_bfe_u32 s29, s2, 0x20003
    s_lshl_b32 s34, s29, 3
    s_lshl_b32 s32, s25, 1
    s_add_u32 s34, s34, s32
    s_add_u32 s39, s34, 1
    s_sub_u32 s38, s28, 48
    s_add_u32 s27, s25, s29
    s_and_b32 s27, s27, 3
    s_lshl_b32 s30, s27, 13
    s_lshl_b32 s32, s27, 3
    s_add_u32 s32, s32, 0
    s_and_b32 s32, s32, 15
    v_xor_b32 v208, s32, v1
    v_lshlrev_b32 v208, 4, v208
    s_lshl_b32 s32, s27, 3
    s_add_u32 s32, s32, 1
    s_and_b32 s32, s32, 15
    v_xor_b32 v209, s32, v1
    v_lshlrev_b32 v209, 4, v209
    s_lshl_b32 s32, s27, 3
    s_add_u32 s32, s32, 2
    s_and_b32 s32, s32, 15
    v_xor_b32 v210, s32, v1
    v_lshlrev_b32 v210, 4, v210
    s_lshl_b32 s32, s27, 3
    s_add_u32 s32, s32, 3
    s_and_b32 s32, s32, 15
    v_xor_b32 v211, s32, v1
    v_lshlrev_b32 v211, 4, v211
    s_lshl_b32 s32, s27, 3
    s_add_u32 s32, s32, 4
    s_and_b32 s32, s32, 15
    v_xor_b32 v212, s32, v1
    v_lshlrev_b32 v212, 4, v212
    s_lshl_b32 s32, s27, 3
    s_add_u32 s32, s32, 5
    s_and_b32 s32, s32, 15
    v_xor_b32 v213, s32, v1
    v_lshlrev_b32 v213, 4, v213
    s_lshl_b32 s32, s27, 3
    s_add_u32 s32, s32, 6
    s_and_b32 s32, s32, 15
    v_xor_b32 v214, s32, v1
    v_lshlrev_b32 v214, 4, v214
    s_lshl_b32 s32, s27, 3
    s_add_u32 s32, s32, 7
    s_and_b32 s32, s32, 15
    v_xor_b32 v215, s32, v1
    v_lshlrev_b32 v215, 4, v215
    v_xor_b32 v4, v13, v14
    v_lshlrev_b32 v4, 4, v4
    v_lshl_or_b32 v60, v13, 10, v4
    v_xor_b32_e64 v61, 64, v60
    v_xor_b32 v62, 128, v60
    v_xor_b32 v63, 192, v60
    s_lshl_b32 s33, s28, 2
    s_add_u32 s50, s33, s29
    s_lshl_b32 s50, s50, 6
    s_cmp_ge_u32 s24, 4
    s_cbranch_scc1 iH_3
    s_lshl_b32 s31, s28, 15
    s_add_u32 s31, s31, s30
    s_waitcnt lgkmcnt(0)
    s_mov_b32 s12, s4
    s_and_b32 s13, s5, 0xffff
    s_mov_b32 s14, 2097152
    s_mov_b32 s15, 0x20000
    s_add_u32 m0, s30, 0
    s_nop 0
    s_nop 0
    buffer_load_dwordx4 v208, s[12:15], s31 offen offset:0 lds
    buffer_load_dwordx4 v209, s[12:15], s31 offen offset:1024 lds
    buffer_load_dwordx4 v210, s[12:15], s31 offen offset:2048 lds
    buffer_load_dwordx4 v211, s[12:15], s31 offen offset:3072 lds
    s_add_u32 m0, s30, 4096
    s_add_u32 s31, s31, 4096
    buffer_load_dwordx4 v212, s[12:15], s31 offen offset:0 lds
    buffer_load_dwordx4 v213, s[12:15], s31 offen offset:1024 lds
    buffer_load_dwordx4 v214, s[12:15], s31 offen offset:2048 lds
    buffer_load_dwordx4 v215, s[12:15], s31 offen offset:3072 lds
    s_mov_b32 s8, s36
    s_and_b32 s9, s37, 0xffff
    s_mov_b32 s10, 50331648
    s_mov_b32 s11, 0x20000
    s_mov_b32 s52, s44
    s_and_b32 s53, s45, 0xffff
    s_mov_b32 s54, 1052672
    s_mov_b32 s55, 0x20000
    s_mov_b32 s16, s46
    s_and_b32 s17, s47, 0xffff
    s_mov_b32 s18, 1052672
    s_mov_b32 s19, 0x20000
    v_mov_b32 v216, 0
    s_mov_b32 s33, 33947648
    buffer_load_dword v217, v216, s[8:11], s33 offen sc1
    v_mov_b32 v4, 94208
    ds_write_b32 v4, v216
    s_call_b64 s[6:7], GEN_F2
    s_lshl_b32 s32, s29, 6
    v_add_u32 v12, s32, v1
    v_cmp_eq_u32 vcc, 0, v12
    v_mov_b32 v15, 256
    s_nop 0
    v_cndmask_b32 v15, v12, v15, vcc
    v_lshlrev_b32_e64 v15, 1, v15
    s_lshl_b32 s33, s28, 3
    s_add_u32 s33, s33, s24
    s_lshr_b32 s31, s33, 7
    s_lshl_b32 s31, s31, 4
    s_and_b32 s32, s33, 15
    s_add_u32 s31, s31, s32
    s_bfe_u32 s32, s33, 0x30004
    s_lshl_b32 s32, s32, 8
    s_add_u32 s31, s31, s32
    s_mul_i32 s48, s31, 514
    buffer_load_ushort v192, v15, s[52:55], s48 offen offset:0
    buffer_load_ushort v196, v15, s[16:19], s48 offen offset:0
    buffer_load_ushort v200, v15, s[52:55], s48 offen offset:2056
    buffer_load_ushort v204, v15, s[16:19], s48 offen offset:2056
    s_add_u32 s48, s48, 32896
    buffer_load_ushort v193, v15, s[52:55], s48 offen offset:0
    buffer_load_ushort v197, v15, s[16:19], s48 offen offset:0
    buffer_load_ushort v201, v15, s[52:55], s48 offen offset:2056
    buffer_load_ushort v205, v15, s[16:19], s48 offen offset:2056
    s_add_u32 s48, s48, 32896
    buffer_load_ushort v194, v15, s[52:55], s48 offen offset:0
    buffer_load_ushort v198, v15, s[16:19], s48 offen offset:0
    buffer_load_ushort v202, v15, s[52:55], s48 offen offset:2056
    buffer_load_ushort v206, v15, s[16:19], s48 offen offset:2056
    s_add_u32 s48, s48, 32896
    buffer_load_ushort v195, v15, s[52:55], s48 offen offset:0
    buffer_load_ushort v199, v15, s[16:19], s48 offen offset:0
    buffer_load_ushort v203, v15, s[52:55], s48 offen offset:2056
    buffer_load_ushort v207, v15, s[16:19], s48 offen offset:2056
    v_mov_b32 v220, -1
    v_mov_b32 v221, -1
    v_mov_b32 v222, -1
    v_mov_b32 v223, -1
    v_and_b32 v5, 255, v0
    v_lshlrev_b32 v5, 4, v5
    s_lshl_b32 s33, s2, 13
    s_add_u32 s33, s33, 2097152
    buffer_store_dwordx4 v[220:223], v5, s[8:11], s33 offen sc1
    s_add_u32 s33, s33, 4096
    buffer_store_dwordx4 v[220:223], v5, s[8:11], s33 offen sc1
    s_lshl_b32 s33, s2, 7
    s_add_u32 s33, s33, 8454144
    s_mov_b64 exec, 0xff
    buffer_store_dwordx4 v[220:223], v6, s[8:11], s33 offen sc1
    s_mov_b64 exec, -1
    s_lshl_b32 s49, s28, 7
    s_add_u32 s49, s49, 12582912
    s_lshl_b32 s33, s24, 11
    s_add_u32 s33, s33, 65536
    v_lshlrev_b32_e64 v7, 5, v13
    v_lshl_or_b32 v7, v14, 3, v7
    v_add_u32_e64 v7, s33, v7
    v_bfe_u32 v8, v1, 2, 2
    v_lshl_add_u32 v8, v14, 3, v8
    v_lshlrev_b32 v8, 5, v8
    v_and_b32 v4, 3, v1
    v_lshl_or_b32 v8, v4, 3, v8
    v_add_u32 v8, s33, v8
    v_lshlrev_b32_e64 v9, 5, v2
    s_lshl_b32 s32, s24, 3
    s_add_u32 s32, s32, 73728
    v_add_u32 v9, s32, v9
    v_or_b32 v4, s34, v14
    v_min_u32 v4, 1, v4
    v_cvt_f32_u32 v10, v4
    v_lshlrev_b32_e64 v11, 6, v13
    v_lshl_or_b32 v11, v14, 4, v11
    s_lshl_b32 s35, s34, 10
    s_lshl_b32 s32, s28, 15
    s_add_u32 s35, s35, s32
    v_mul_u32_u24 v208, 144, v1
    s_lshl_b32 s32, s24, 4
    s_add_u32 s32, s32, 74752
    v_add_u32 v208, s32, v208
    v_lshrrev_b32 v4, 3, v0
    v_and_b32_e64 v5, 7, v0
    v_mul_u32_u24 v209, 144, v4
    v_lshl_add_u32 v209, v5, 4, v209
    v_add_u32 v209, 74752, v209
    s_lshl_b32 s32, s29, 6
    v_add_u32 v4, s32, v4
    v_lshlrev_b32_e64 v210, 13, v4
    v_lshl_or_b32 v210, v5, 4, v210
    s_waitcnt vmcnt(20) lgkmcnt(0)
    s_barrier
    ds_read_b128 v[32:35], v60 offset:0
    ds_read_b128 v[36:39], v60 offset:16384
    ds_read_b128 v[40:43], v61 offset:0
    ds_read_b128 v[44:47], v61 offset:16384
    ds_read_b128 v[48:51], v62 offset:0
    ds_read_b128 v[52:55], v62 offset:16384
    s_waitcnt lgkmcnt(5)
    v_mfma_f32_16x16x32_bf16 v[16:19], v[64:67], v[32:35], 0
    ds_read_b128 v[56:59], v63 offset:0
    v_mfma_f32_16x16x32_bf16 v[24:27], v[128:131], v[32:35], 0
    s_waitcnt lgkmcnt(5)
    v_mfma_f32_16x16x32_bf16 v[20:23], v[64:67], v[36:39], 0
    ds_read_b128 v[32:35], v63 offset:16384
    v_mfma_f32_16x16x32_bf16 v[28:31], v[128:131], v[36:39], 0
    s_waitcnt lgkmcnt(5)
    v_mfma_f32_16x16x32_bf16 v[16:19], v[68:71], v[40:43], v[16:19]
    ds_read_b128 v[36:39], v60 offset:256
    v_mfma_f32_16x16x32_bf16 v[24:27], v[132:135], v[40:43], v[24:27]
    s_waitcnt lgkmcnt(5)
    v_mfma_f32_16x16x32_bf16 v[20:23], v[68:71], v[44:47], v[20:23]
    ds_read_b128 v[40:43], v60 offset:16640
    v_mfma_f32_16x16x32_bf16 v[28:31], v[132:135], v[44:47], v[28:31]
    s_waitcnt lgkmcnt(5)
    v_mfma_f32_16x16x32_bf16 v[16:19], v[72:75], v[48:51], v[16:19]
    ds_read_b128 v[44:47], v61 offset:256
    v_mfma_f32_16x16x32_bf16 v[24:27], v[136:139], v[48:51], v[24:27]
    s_waitcnt lgkmcnt(5)
    v_mfma_f32_16x16x32_bf16 v[20:23], v[72:75], v[52:55], v[20:23]
    ds_read_b128 v[48:51], v61 offset:16640
    v_mfma_f32_16x16x32_bf16 v[28:31], v[136:139], v[52:55], v[28:31]
    s_waitcnt lgkmcnt(5)
    v_mfma_f32_16x16x32_bf16 v[16:19], v[76:79], v[56:59], v[16:19]
    ds_read_b128 v[52:55], v62 offset:256
    v_mfma_f32_16x16x32_bf16 v[24:27], v[140:143], v[56:59], v[24:27]
    s_waitcnt lgkmcnt(5)
    v_mfma_f32_16x16x32_bf16 v[20:23], v[76:79], v[32:35], v[20:23]
    ds_read_b128 v[56:59], v62 offset:16640
    v_mfma_f32_16x16x32_bf16 v[28:31], v[140:143], v[32:35], v[28:31]
    s_waitcnt lgkmcnt(5)
    v_mfma_f32_16x16x32_bf16 v[16:19], v[80:83], v[36:39], v[16:19]
    ds_read_b128 v[32:35], v63 offset:256
    v_mfma_f32_16x16x32_bf16 v[24:27], v[144:147], v[36:39], v[24:27]
    s_waitcnt lgkmcnt(5)
    v_mfma_f32_16x16x32_bf16 v[20:23], v[80:83], v[40:43], v[20:23]
    ds_read_b128 v[36:39], v63 offset:16640
    v_mfma_f32_16x16x32_bf16 v[28:31], v[144:147], v[40:43], v[28:31]
    s_waitcnt lgkmcnt(5)
    v_mfma_f32_16x16x32_bf16 v[16:19], v[84:87], v[44:47], v[16:19]
    ds_read_b128 v[40:43], v60 offset:512
    v_mfma_f32_16x16x32_bf16 v[24:27], v[148:151], v[44:47], v[24:27]
    s_waitcnt lgkmcnt(5)
    v_mfma_f32_16x16x32_bf16 v[20:23], v[84:87], v[48:51], v[20:23]
    ds_read_b128 v[44:47], v60 offset:16896
    v_mfma_f32_16x16x32_bf16 v[28:31], v[148:151], v[48:51], v[28:31]
    s_waitcnt lgkmcnt(5)
    v_mfma_f32_16x16x32_bf16 v[16:19], v[88:91], v[52:55], v[16:19]
    ds_read_b128 v[48:51], v61 offset:512
    v_mfma_f32_16x16x32_bf16 v[24:27], v[152:155], v[52:55], v[24:27]
    s_waitcnt lgkmcnt(5)
    v_mfma_f32_16x16x32_bf16 v[20:23], v[88:91], v[56:59], v[20:23]
    ds_read_b128 v[52:55], v61 offset:16896
    v_mfma_f32_16x16x32_bf16 v[28:31], v[152:155], v[56:59], v[28:31]
    s_waitcnt lgkmcnt(5)
    v_mfma_f32_16x16x32_bf16 v[16:19], v[92:95], v[32:35], v[16:19]
    ds_read_b128 v[56:59], v62 offset:512
    v_mfma_f32_16x16x32_bf16 v[24:27], v[156:159], v[32:35], v[24:27]
    s_waitcnt lgkmcnt(5)
    v_mfma_f32_16x16x32_bf16 v[20:23], v[92:95], v[36:39], v[20:23]
    ds_read_b128 v[32:35], v62 offset:16896
    v_mfma_f32_16x16x32_bf16 v[28:31], v[156:159], v[36:39], v[28:31]
    s_waitcnt lgkmcnt(5)
    v_mfma_f32_16x16x32_bf16 v[16:19], v[96:99], v[40:43], v[16:19]
    ds_read_b128 v[36:39], v63 offset:512
    v_mfma_f32_16x16x32_bf16 v[24:27], v[160:163], v[40:43], v[24:27]
    s_waitcnt lgkmcnt(5)
    v_mfma_f32_16x16x32_bf16 v[20:23], v[96:99], v[44:47], v[20:23]
    ds_read_b128 v[40:43], v63 offset:16896
    v_mfma_f32_16x16x32_bf16 v[28:31], v[160:163], v[44:47], v[28:31]
    s_waitcnt lgkmcnt(5)
    v_mfma_f32_16x16x32_bf16 v[16:19], v[100:103], v[48:51], v[16:19]
    ds_read_b128 v[44:47], v60 offset:768
    v_mfma_f32_16x16x32_bf16 v[24:27], v[164:167], v[48:51], v[24:27]
    s_waitcnt lgkmcnt(5)
    v_mfma_f32_16x16x32_bf16 v[20:23], v[100:103], v[52:55], v[20:23]
    ds_read_b128 v[48:51], v60 offset:17152
    v_mfma_f32_16x16x32_bf16 v[28:31], v[164:167], v[52:55], v[28:31]
    s_waitcnt lgkmcnt(5)
    v_mfma_f32_16x16x32_bf16 v[16:19], v[104:107], v[56:59], v[16:19]
    ds_read_b128 v[52:55], v61 offset:768
    v_mfma_f32_16x16x32_bf16 v[24:27], v[168:171], v[56:59], v[24:27]
    s_waitcnt lgkmcnt(5)
    v_mfma_f32_16x16x32_bf16 v[20:23], v[104:107], v[32:35], v[20:23]
    ds_read_b128 v[56:59], v61 offset:17152
    v_mfma_f32_16x16x32_bf16 v[28:31], v[168:171], v[32:35], v[28:31]
    s_waitcnt lgkmcnt(5)
    v_mfma_f32_16x16x32_bf16 v[16:19], v[108:111], v[36:39], v[16:19]
    ds_read_b128 v[32:35], v62 offset:768
    v_mfma_f32_16x16x32_bf16 v[24:27], v[172:175], v[36:39], v[24:27]
    s_waitcnt lgkmcnt(5)
    v_mfma_f32_16x16x32_bf16 v[20:23], v[108:111], v[40:43], v[20:23]
    ds_read_b128 v[36:39], v62 offset:17152
    v_mfma_f32_16x16x32_bf16 v[28:31], v[172:175], v[40:43], v[28:31]
    s_waitcnt lgkmcnt(5)
    v_mfma_f32_16x16x32_bf16 v[16:19], v[112:115], v[44:47], v[16:19]
    ds_read_b128 v[40:43], v63 offset:768
    v_mfma_f32_16x16x32_bf16 v[24:27], v[176:179], v[44:47], v[24:27]
    s_waitcnt lgkmcnt(5)
    v_mfma_f32_16x16x32_bf16 v[20:23], v[112:115], v[48:51], v[20:23]
    ds_read_b128 v[44:47], v63 offset:17152
    v_mfma_f32_16x16x32_bf16 v[28:31], v[176:179], v[48:51], v[28:31]
    s_waitcnt lgkmcnt(5)
    v_mfma_f32_16x16x32_bf16 v[16:19], v[116:119], v[52:55], v[16:19]
    v_mfma_f32_16x16x32_bf16 v[24:27], v[180:183], v[52:55], v[24:27]
    s_waitcnt lgkmcnt(4)
    v_mfma_f32_16x16x32_bf16 v[20:23], v[116:119], v[56:59], v[20:23]
    v_mfma_f32_16x16x32_bf16 v[28:31], v[180:183], v[56:59], v[28:31]
    s_waitcnt lgkmcnt(3)
    v_mfma_f32_16x16x32_bf16 v[16:19], v[120:123], v[32:35], v[16:19]
    v_mfma_f32_16x16x32_bf16 v[24:27], v[184:187], v[32:35], v[24:27]
    s_waitcnt lgkmcnt(2)
    v_mfma_f32_16x16x32_bf16 v[20:23], v[120:123], v[36:39], v[20:23]
    v_mfma_f32_16x16x32_bf16 v[28:31], v[184:187], v[36:39], v[28:31]
    s_waitcnt lgkmcnt(1)
    v_mfma_f32_16x16x32_bf16 v[16:19], v[124:127], v[40:43], v[16:19]
    v_mfma_f32_16x16x32_bf16 v[24:27], v[188:191], v[40:43], v[24:27]
    s_waitcnt lgkmcnt(0)
    v_mfma_f32_16x16x32_bf16 v[20:23], v[124:127], v[44:47], v[20:23]
    v_mfma_f32_16x16x32_bf16 v[28:31], v[188:191], v[44:47], v[28:31]
    s_nop 3
    s_nop 0
    v_cvt_pk_bf16_f32 v32, v16, v17
    v_cvt_pk_bf16_f32 v33, v18, v19
    ds_write_b64 v7, v[32:33] offset:0
    v_cvt_pk_bf16_f32 v34, v20, v21
    v_cvt_pk_bf16_f32 v35, v22, v23
    ds_write_b64 v7, v[34:35] offset:512
    v_cvt_pk_bf16_f32 v36, v24, v25
    v_cvt_pk_bf16_f32 v37, v26, v27
    ds_write_b64 v7, v[36:37] offset:1024
    v_cvt_pk_bf16_f32 v38, v28, v29
    v_cvt_pk_bf16_f32 v39, v30, v31
    ds_write_b64 v7, v[38:39] offset:1536
    v_mul_f32 v40, v16, v10
    v_mul_f32 v40, v40, v16
    v_fmac_f32 v40, v17, v17
    v_fmac_f32 v40, v18, v18
    v_fmac_f32 v40, v19, v19
    v_mul_f32 v41, v20, v10
    v_mul_f32 v41, v41, v20
    v_fmac_f32 v41, v21, v21
    v_fmac_f32 v41, v22, v22
    v_fmac_f32 v41, v23, v23
    v_mul_f32 v42, v24, v24
    v_fmac_f32 v42, v25, v25
    v_fmac_f32 v42, v26, v26
    v_fmac_f32 v42, v27, v27
    v_mul_f32_e64 v43, v28, v28
    v_fmac_f32 v43, v29, v29
    v_fmac_f32 v43, v30, v30
    v_fmac_f32 v43, v31, v31
    s_waitcnt lgkmcnt(0)
    ds_read_b64_tr_b16 v[32:33], v8 offset:0
    ds_read_b64_tr_b16 v[34:35], v8 offset:128
    ds_read_b64_tr_b16 v[36:37], v8 offset:1024
    ds_read_b64_tr_b16 v[38:39], v8 offset:1152
    v_add_f32 v40, v40, v42
    v_add_f32 v41, v41, v43
    s_nop 1
    v_permlane16_swap_b32 v40, v41
    v_add_f32 v40, v40, v41
    v_mov_b32 v41, v40
    s_nop 1
    v_permlane32_swap_b32 v40, v41
    v_add_f32 v40, v40, v41
    v_mov_b32 v41, 0
    ds_write_b64 v9, v[40:41]
    s_waitcnt lgkmcnt(1)
    buffer_store_dwordx4 v[32:35], v11, s[8:11], s35 offen offset:0 sc1
    buffer_store_dwordx4 v[36:39], v11, s[8:11], s35 offen offset:1024 sc1
    s_waitcnt vmcnt(5)
    v_lshl_or_b32 v192, v196, 16, v192
    v_lshl_or_b32 v193, v197, 16, v193
    v_lshl_or_b32 v194, v198, 16, v194
    v_lshl_or_b32 v195, v199, 16, v195
    ds_write_b128 v208, v[192:195] offset:0
    v_lshl_or_b32 v200, v204, 16, v200
    v_lshl_or_b32 v201, v205, 16, v201
    v_lshl_or_b32 v202, v206, 16, v202
    v_lshl_or_b32 v203, v207, 16, v203
    ds_write_b128 v208, v[200:203] offset:64
    s_waitcnt lgkmcnt(0)
    s_barrier
    ds_read_b128 v[192:195], v209
    ds_read_b128 v[196:199], v209 offset:4608
    s_cmp_lg_u32 s24, 0
    s_cbranch_scc1 sk_6
    v_lshlrev_b32_e64 v5, 5, v2
    v_lshl_or_b32 v5, v3, 4, v5
    v_add_u32 v5, 73728, v5
    ds_read_b128 v[48:51], v5
    v_lshlrev_b32 v4, 2, v2
    s_lshl_b32 s32, s29, 13
    s_lshl_b32 s33, s28, 7
    s_add_u32 s32, s32, s33
    s_add_u32 s32, s32, 8388608
    s_waitcnt lgkmcnt(0)
    v_add_f32 v48, v48, v49
    v_add_f32 v50, v50, v51
    v_add_f32 v48, v48, v50
    v_mov_b32 v5, v48
    s_nop 1
    v_permlane32_swap_b32 v48, v5
    v_add_f32 v5, v48, v5
    buffer_store_dword v5, v4, s[8:11], s32 offen sc1
sk_6:
    s_add_u32 s33, s49, 0x40000
    s_waitcnt lgkmcnt(0)
    buffer_store_dwordx4 v[192:195], v210, s[8:11], s49 offen sc1
    buffer_store_dwordx4 v[196:199], v210, s[8:11], s33 offen sc1
    s_add_u32 s50, s50, 33816576
    v_readfirstlane_b32 s36, v217
    s_nop 0
    s_mul_i32 s36, s36, 0x9e3779b1
    s_add_u32 s36, s36, 0x7f4a7c15
    v_mov_b32 v52, s36
    v_mov_b32_e64 v53, 0
    v_mov_b32 v4, 94208
    v_mov_b32_e64 v5, 1
    s_waitcnt vmcnt(0)
    s_mov_b64 exec, 1
    ds_add_rtn_u32 v5, v4, v5
    s_waitcnt lgkmcnt(0)
    v_cmp_eq_u32 vcc, 3, v5
    s_nop 0
    s_and_b64 exec, vcc, 1
    buffer_store_dword v52, v53, s[8:11], s50 offen sc1
    s_mov_b64 exec, -1
    s_barrier
    s_branch iend_5
iH_3:
    s_waitcnt lgkmcnt(0)
    s_mov_b32 s12, s40
    s_and_b32 s13, s41, 0xffff
    s_mov_b32 s14, 1572864
    s_mov_b32 s15, 0x20000
    s_mov_b32 s20, s42
    s_and_b32 s21, s43, 0xffff
    s_mov_b32 s22, 524288
    s_mov_b32 s23, 0x20000
    s_cmp_lg_u32 s24, 4
    s_cbranch_scc1 nt_7
    s_cmp_ge_u32 s28, 48
    s_cbranch_scc1 nt_7
    v_lshrrev_b32_e64 v4, 2, v1
    v_mul_u32_u24 v4, 3072, v4
    v_and_b32_e64 v7, 3, v1
    v_lshl_add_u32 v4, v7, 7, v4
    s_and_b32 s32, s2, 7
    s_lshr_b32 s33, s2, 3
    s_mul_i32 s33, s33, 49152
    s_lshl_b32 s32, s32, 9
    s_add_u32 s33, s33, s32
    buffer_load_dword v204, v4, s[12:15], s33 offen
nt_7:
    s_mov_b32 s8, s36
    s_and_b32 s9, s37, 0xffff
    s_mov_b32 s10, 50331648
    s_mov_b32 s11, 0x20000
    v_mov_b32 v216, 0
    s_mov_b32 s33, 33947648
    buffer_load_dword v217, v216, s[8:11], s33 offen sc1
    s_call_b64 s[6:7], GEN_F2
    s_barrier
    s_cmp_ge_u32 s28, 48
    s_cbranch_scc1 wo_9
    v_lshrrev_b32_e64 v4, 2, v1
    v_mul_u32_u24 v4, 3072, v4
    v_and_b32_e64 v5, 3, v1
    v_lshl_add_u32 v4, v5, 4, v4
    s_mul_i32 s31, s27, 393216
    s_lshl_b32 s32, s28, 6
    s_add_u32 s31, s31, s32
    s_add_u32 m0, s30, 32768
    s_nop 0
    buffer_load_dwordx4 v4, s[12:15], s31 offen lds
    s_add_u32 s31, s31, 49152
    s_add_u32 m0, s30, 33792
    s_nop 0
    buffer_load_dwordx4 v4, s[12:15], s31 offen lds
    s_add_u32 s31, s31, 49152
    s_add_u32 m0, s30, 34816
    s_nop 0
    buffer_load_dwordx4 v4, s[12:15], s31 offen lds
    s_add_u32 s31, s31, 49152
    s_add_u32 m0, s30, 35840
    s_nop 0
    buffer_load_dwordx4 v4, s[12:15], s31 offen lds
    s_add_u32 s31, s31, 49152
    s_add_u32 m0, s30, 36864
    s_nop 0
    buffer_load_dwordx4 v4, s[12:15], s31 offen lds
    s_add_u32 s31, s31, 49152
    s_add_u32 m0, s30, 37888
    s_nop 0
    buffer_load_dwordx4 v4, s[12:15], s31 offen lds
    s_add_u32 s31, s31, 49152
    s_add_u32 m0, s30, 38912
    s_nop 0
    buffer_load_dwordx4 v4, s[12:15], s31 offen lds
    s_add_u32 s31, s31, 49152
    s_add_u32 m0, s30, 39936
    s_nop 0
    buffer_load_dwordx4 v4, s[12:15], s31 offen lds
    s_branch wj_10
wo_9:
    s_lshl_b32 s31, s38, 15
    s_add_u32 s31, s31, s30
    s_add_u32 m0, s30, 32768
    s_nop 0
    buffer_load_dwordx4 v208, s[20:23], s31 offen offset:0 lds
    buffer_load_dwordx4 v209, s[20:23], s31 offen offset:1024 lds
    buffer_load_dwordx4 v210, s[20:23], s31 offen offset:2048 lds
    buffer_load_dwordx4 v211, s[20:23], s31 offen offset:3072 lds
    s_add_u32 m0, s30, 36864
    s_add_u32 s31, s31, 4096
    buffer_load_dwordx4 v212, s[20:23], s31 offen offset:0 lds
    buffer_load_dwordx4 v213, s[20:23], s31 offen offset:1024 lds
    buffer_load_dwordx4 v214, s[20:23], s31 offen offset:2048 lds
    buffer_load_dwordx4 v215, s[20:23], s31 offen offset:3072 lds
wj_10:
    s_and_b32 s48, s24, 1
    s_and_b32 s32, s2, 7
    s_lshl_b32 s32, s32, 1
    s_add_u32 s51, s32, s48
    s_lshr_b32 s3, s2, 3
    v_lshrrev_b32 v4, 1, v1
    v_lshlrev_b32 v4, 10, v4
    v_and_b32 v5, 1, v1
    v_lshl_or_b32 v4, v5, 4, v4
    s_lshl_b32 s32, s51, 15
    s_lshl_b32 s33, s3, 5
    s_add_u32 s32, s32, s33
    s_lshl_b32 s48, s48, 10
    s_add_u32 s48, s48, 83968
    s_cmp_ge_u32 s24, 6
    s_cselect_b32 s32, 0x7ff00000, s32
    s_cselect_b32 m0, 0x17800, s48
    s_nop 0
    buffer_load_dwordx4 v4, s[20:23], s32 offen lds
    v_bfe_u32 v7, v1, 2, 2
    v_lshl_add_u32 v7, v14, 3, v7
    v_lshlrev_b32 v7, 6, v7
    v_and_b32 v8, 3, v1
    v_lshl_or_b32 v7, v8, 3, v7
    s_barrier
    s_waitcnt vmcnt(0)
    v_readfirstlane_b32 s36, v217
    s_nop 0
    s_mul_i32 s36, s36, 0x9e3779b1
    s_add_u32 s36, s36, 0x7f4a7c15
    v_mov_b32 v52, s36
    v_mov_b32_e64 v53, 0
    s_barrier
    s_cmp_ge_u32 s28, 48
    s_cbranch_scc1 wo2_11
    s_lshl_b32 s35, s28, 15
    s_lshr_b32 s32, s34, 1
    s_lshl_b32 s32, s32, 10
    s_add_u32 s35, s35, s32
    s_add_u32 s35, s35, 9437184
    s_add_u32 s49, s35, 16384
    ds_read_b64_tr_b16 v[32:33], v7 offset:32768
    ds_read_b64_tr_b16 v[34:35], v7 offset:33024
    ds_read_b64_tr_b16 v[36:37], v7 offset:32800
    ds_read_b64_tr_b16 v[38:39], v7 offset:33056
    ds_read_b64_tr_b16 v[40:41], v7 offset:34816
    ds_read_b64_tr_b16 v[42:43], v7 offset:35072
    ds_read_b64_tr_b16 v[44:45], v7 offset:34848
    ds_read_b64_tr_b16 v[46:47], v7 offset:35104
    ds_read_b64_tr_b16 v[48:49], v7 offset:36864
    ds_read_b64_tr_b16 v[50:51], v7 offset:37120
    ds_read_b64_tr_b16 v[52:53], v7 offset:36896
    ds_read_b64_tr_b16 v[54:55], v7 offset:37152
    s_waitcnt lgkmcnt(10)
    v_mfma_f32_16x16x32_bf16 v[16:19], v[64:67], v[32:35], 0
    ds_read_b64_tr_b16 v[56:57], v7 offset:38912
    ds_read_b64_tr_b16 v[58:59], v7 offset:39168
    v_mfma_f32_16x16x32_bf16 v[24:27], v[128:131], v[32:35], 0
    s_waitcnt lgkmcnt(10)
    v_mfma_f32_16x16x32_bf16 v[20:23], v[64:67], v[36:39], 0
    ds_read_b64_tr_b16 v[32:33], v7 offset:38944
    ds_read_b64_tr_b16 v[34:35], v7 offset:39200
    v_mfma_f32_16x16x32_bf16 v[28:31], v[128:131], v[36:39], 0
    s_waitcnt lgkmcnt(10)
    v_mfma_f32_16x16x32_bf16 v[16:19], v[68:71], v[40:43], v[16:19]
    ds_read_b64_tr_b16 v[36:37], v7 offset:40960
    ds_read_b64_tr_b16 v[38:39], v7 offset:41216
    v_mfma_f32_16x16x32_bf16 v[24:27], v[132:135], v[40:43], v[24:27]
    s_waitcnt lgkmcnt(10)
    v_mfma_f32_16x16x32_bf16 v[20:23], v[68:71], v[44:47], v[20:23]
    ds_read_b64_tr_b16 v[40:41], v7 offset:40992
    ds_read_b64_tr_b16 v[42:43], v7 offset:41248
    v_mfma_f32_16x16x32_bf16 v[28:31], v[132:135], v[44:47], v[28:31]
    s_waitcnt lgkmcnt(10)
    v_mfma_f32_16x16x32_bf16 v[16:19], v[72:75], v[48:51], v[16:19]
    ds_read_b64_tr_b16 v[44:45], v7 offset:43008
    ds_read_b64_tr_b16 v[46:47], v7 offset:43264
    v_mfma_f32_16x16x32_bf16 v[24:27], v[136:139], v[48:51], v[24:27]
    s_waitcnt lgkmcnt(10)
    v_mfma_f32_16x16x32_bf16 v[20:23], v[72:75], v[52:55], v[20:23]
    ds_read_b64_tr_b16 v[48:49], v7 offset:43040
    ds_read_b64_tr_b16 v[50:51], v7 offset:43296
    v_mfma_f32_16x16x32_bf16 v[28:31], v[136:139], v[52:55], v[28:31]
    s_waitcnt lgkmcnt(10)
    v_mfma_f32_16x16x32_bf16 v[16:19], v[76:79], v[56:59], v[16:19]
    ds_read_b64_tr_b16 v[52:53], v7 offset:45056
    ds_read_b64_tr_b16 v[54:55], v7 offset:45312
    v_mfma_f32_16x16x32_bf16 v[24:27], v[140:143], v[56:59], v[24:27]
    s_waitcnt lgkmcnt(10)
    v_mfma_f32_16x16x32_bf16 v[20:23], v[76:79], v[32:35], v[20:23]
    ds_read_b64_tr_b16 v[56:57], v7 offset:45088
    ds_read_b64_tr_b16 v[58:59], v7 offset:45344
    v_mfma_f32_16x16x32_bf16 v[28:31], v[140:143], v[32:35], v[28:31]
    s_waitcnt lgkmcnt(10)
    v_mfma_f32_16x16x32_bf16 v[16:19], v[80:83], v[36:39], v[16:19]
    ds_read_b64_tr_b16 v[32:33], v7 offset:47104
    ds_read_b64_tr_b16 v[34:35], v7 offset:47360
    v_mfma_f32_16x16x32_bf16 v[24:27], v[144:147], v[36:39], v[24:27]
    s_waitcnt lgkmcnt(10)
    v_mfma_f32_16x16x32_bf16 v[20:23], v[80:83], v[40:43], v[20:23]
    ds_read_b64_tr_b16 v[36:37], v7 offset:47136
    ds_read_b64_tr_b16 v[38:39], v7 offset:47392
    v_mfma_f32_16x16x32_bf16 v[28:31], v[144:147], v[40:43], v[28:31]
    s_waitcnt lgkmcnt(10)
    v_mfma_f32_16x16x32_bf16 v[16:19], v[84:87], v[44:47], v[16:19]
    ds_read_b64_tr_b16 v[40:41], v7 offset:49152
    ds_read_b64_tr_b16 v[42:43], v7 offset:49408
    v_mfma_f32_16x16x32_bf16 v[24:27], v[148:151], v[44:47], v[24:27]
    s_waitcnt lgkmcnt(10)
    v_mfma_f32_16x16x32_bf16 v[20:23], v[84:87], v[48:51], v[20:23]
    ds_read_b64_tr_b16 v[44:45], v7 offset:49184
    ds_read_b64_tr_b16 v[46:47], v7 offset:49440
    v_mfma_f32_16x16x32_bf16 v[28:31], v[148:151], v[48:51], v[28:31]
    s_waitcnt lgkmcnt(10)
    v_mfma_f32_16x16x32_bf16 v[16:19], v[88:91], v[52:55], v[16:19]
    ds_read_b64_tr_b16 v[48:49], v7 offset:51200
    ds_read_b64_tr_b16 v[50:51], v7 offset:51456
    v_mfma_f32_16x16x32_bf16 v[24:27], v[152:155], v[52:55], v[24:27]
    s_waitcnt lgkmcnt(10)
    v_mfma_f32_16x16x32_bf16 v[20:23], v[88:91], v[56:59], v[20:23]
    ds_read_b64_tr_b16 v[52:53], v7 offset:51232
    ds_read_b64_tr_b16 v[54:55], v7 offset:51488
    v_mfma_f32_16x16x32_bf16 v[28:31], v[152:155], v[56:59], v[28:31]
    s_waitcnt lgkmcnt(10)
    v_mfma_f32_16x16x32_bf16 v[16:19], v[92:95], v[32:35], v[16:19]
    ds_read_b64_tr_b16 v[56:57], v7 offset:53248
    ds_read_b64_tr_b16 v[58:59], v7 offset:53504
    v_mfma_f32_16x16x32_bf16 v[24:27], v[156:159], v[32:35], v[24:27]
    s_waitcnt lgkmcnt(10)
    v_mfma_f32_16x16x32_bf16 v[20:23], v[92:95], v[36:39], v[20:23]
    ds_read_b64_tr_b16 v[32:33], v7 offset:53280
    ds_read_b64_tr_b16 v[34:35], v7 offset:53536
    v_mfma_f32_16x16x32_bf16 v[28:31], v[156:159], v[36:39], v[28:31]
    s_waitcnt lgkmcnt(10)
    v_mfma_f32_16x16x32_bf16 v[16:19], v[96:99], v[40:43], v[16:19]
    ds_read_b64_tr_b16 v[36:37], v7 offset:55296
    ds_read_b64_tr_b16 v[38:39], v7 offset:55552
    v_mfma_f32_16x16x32_bf16 v[24:27], v[160:163], v[40:43], v[24:27]
    s_waitcnt lgkmcnt(10)
    v_mfma_f32_16x16x32_bf16 v[20:23], v[96:99], v[44:47], v[20:23]
    ds_read_b64_tr_b16 v[40:41], v7 offset:55328
    ds_read_b64_tr_b16 v[42:43], v7 offset:55584
    v_mfma_f32_16x16x32_bf16 v[28:31], v[160:163], v[44:47], v[28:31]
    s_waitcnt lgkmcnt(10)
    v_mfma_f32_16x16x32_bf16 v[16:19], v[100:103], v[48:51], v[16:19]
    ds_read_b64_tr_b16 v[44:45], v7 offset:57344
    ds_read_b64_tr_b16 v[46:47], v7 offset:57600
    v_mfma_f32_16x16x32_bf16 v[24:27], v[164:167], v[48:51], v[24:27]
    s_waitcnt lgkmcnt(10)
    v_mfma_f32_16x16x32_bf16 v[20:23], v[100:103], v[52:55], v[20:23]
    ds_read_b64_tr_b16 v[48:49], v7 offset:57376
    ds_read_b64_tr_b16 v[50:51], v7 offset:57632
    v_mfma_f32_16x16x32_bf16 v[28:31], v[164:167], v[52:55], v[28:31]
    s_waitcnt lgkmcnt(10)
    v_mfma_f32_16x16x32_bf16 v[16:19], v[104:107], v[56:59], v[16:19]
    ds_read_b64_tr_b16 v[52:53], v7 offset:59392
    ds_read_b64_tr_b16 v[54:55], v7 offset:59648
    v_mfma_f32_16x16x32_bf16 v[24:27], v[168:171], v[56:59], v[24:27]
    s_waitcnt lgkmcnt(10)
    v_mfma_f32_16x16x32_bf16 v[20:23], v[104:107], v[32:35], v[20:23]
    ds_read_b64_tr_b16 v[56:57], v7 offset:59424
    ds_read_b64_tr_b16 v[58:59], v7 offset:59680
    v_mfma_f32_16x16x32_bf16 v[28:31], v[168:171], v[32:35], v[28:31]
    s_waitcnt lgkmcnt(10)
    v_mfma_f32_16x16x32_bf16 v[16:19], v[108:111], v[36:39], v[16:19]
    ds_read_b64_tr_b16 v[32:33], v7 offset:61440
    ds_read_b64_tr_b16 v[34:35], v7 offset:61696
    v_mfma_f32_16x16x32_bf16 v[24:27], v[172:175], v[36:39], v[24:27]
    s_waitcnt lgkmcnt(10)
    v_mfma_f32_16x16x32_bf16 v[20:23], v[108:111], v[40:43], v[20:23]
    ds_read_b64_tr_b16 v[36:37], v7 offset:61472
    ds_read_b64_tr_b16 v[38:39], v7 offset:61728
    v_mfma_f32_16x16x32_bf16 v[28:31], v[172:175], v[40:43], v[28:31]
    s_waitcnt lgkmcnt(10)
    v_mfma_f32_16x16x32_bf16 v[16:19], v[112:115], v[44:47], v[16:19]
    ds_read_b64_tr_b16 v[40:41], v7 offset:63488
    ds_read_b64_tr_b16 v[42:43], v7 offset:63744
    v_mfma_f32_16x16x32_bf16 v[24:27], v[176:179], v[44:47], v[24:27]
    s_waitcnt lgkmcnt(10)
    v_mfma_f32_16x16x32_bf16 v[20:23], v[112:115], v[48:51], v[20:23]
    ds_read_b64_tr_b16 v[44:45], v7 offset:63520
    ds_read_b64_tr_b16 v[46:47], v7 offset:63776
    v_mfma_f32_16x16x32_bf16 v[28:31], v[176:179], v[48:51], v[28:31]
    s_waitcnt lgkmcnt(10)
    v_mfma_f32_16x16x32_bf16 v[16:19], v[116:119], v[52:55], v[16:19]
    v_mfma_f32_16x16x32_bf16 v[24:27], v[180:183], v[52:55], v[24:27]
    s_waitcnt lgkmcnt(8)
    v_mfma_f32_16x16x32_bf16 v[20:23], v[116:119], v[56:59], v[20:23]
    v_mfma_f32_16x16x32_bf16 v[28:31], v[180:183], v[56:59], v[28:31]
    s_waitcnt lgkmcnt(6)
    v_mfma_f32_16x16x32_bf16 v[16:19], v[120:123], v[32:35], v[16:19]
    v_mfma_f32_16x16x32_bf16 v[24:27], v[184:187], v[32:35], v[24:27]
    s_waitcnt lgkmcnt(4)
    v_mfma_f32_16x16x32_bf16 v[20:23], v[120:123], v[36:39], v[20:23]
    v_mfma_f32_16x16x32_bf16 v[28:31], v[184:187], v[36:39], v[28:31]
    s_waitcnt lgkmcnt(2)
    v_mfma_f32_16x16x32_bf16 v[16:19], v[124:127], v[40:43], v[16:19]
    v_mfma_f32_16x16x32_bf16 v[24:27], v[188:191], v[40:43], v[24:27]
    s_waitcnt lgkmcnt(0)
    v_mfma_f32_16x16x32_bf16 v[20:23], v[124:127], v[44:47], v[20:23]
    v_mfma_f32_16x16x32_bf16 v[28:31], v[188:191], v[44:47], v[28:31]
    s_nop 3
    s_nop 0
    v_cvt_pk_bf16_f32 v40, v16, v17
    v_cvt_pk_bf16_f32 v41, v18, v19
    v_cvt_pk_bf16_f32 v42, v24, v25
    v_cvt_pk_bf16_f32 v43, v26, v27
    v_cvt_pk_bf16_f32 v44, v20, v21
    v_cvt_pk_bf16_f32 v45, v22, v23
    v_cvt_pk_bf16_f32 v46, v28, v29
    v_cvt_pk_bf16_f32 v47, v30, v31
    s_branch fin_12
wo2_11:
    v_lshrrev_b32 v5, 1, v14
    v_lshlrev_b32 v5, 3, v5
    v_and_b32 v4, 1, v14
    v_lshl_or_b32 v9, v4, 4, v13
    v_lshl_or_b32 v9, v9, 4, v5
    s_lshl_b32 s32, s25, 11
    s_add_u32 s32, s32, 86016
    v_add_u32 v9, s32, v9
    v_add_u32 v10, s32, v6
    s_lshl_b32 s35, s34, 4
    s_add_u32 s35, s35, s38
    s_lshl_b32 s35, s35, 10
    s_add_u32 s35, s35, 11534336
    s_add_u32 s49, s35, 16384
    ds_read_b128 v[32:35], v60 offset:32768
    ds_read_b128 v[36:39], v60 offset:49152
    ds_read_b128 v[40:43], v61 offset:32768
    ds_read_b128 v[44:47], v61 offset:49152
    ds_read_b128 v[48:51], v62 offset:32768
    ds_read_b128 v[52:55], v62 offset:49152
    s_waitcnt lgkmcnt(5)
    v_mfma_f32_16x16x32_bf16 v[16:19], v[32:35], v[64:67], 0
    ds_read_b128 v[56:59], v63 offset:32768
    v_mfma_f32_16x16x32_bf16 v[24:27], v[32:35], v[128:131], 0
    s_waitcnt lgkmcnt(5)
    v_mfma_f32_16x16x32_bf16 v[20:23], v[36:39], v[64:67], 0
    ds_read_b128 v[32:35], v63 offset:49152
    v_mfma_f32_16x16x32_bf16 v[28:31], v[36:39], v[128:131], 0
    s_waitcnt lgkmcnt(5)
    v_mfma_f32_16x16x32_bf16 v[16:19], v[40:43], v[68:71], v[16:19]
    ds_read_b128 v[36:39], v60 offset:33024
    v_mfma_f32_16x16x32_bf16 v[24:27], v[40:43], v[132:135], v[24:27]
    s_waitcnt lgkmcnt(5)
    v_mfma_f32_16x16x32_bf16 v[20:23], v[44:47], v[68:71], v[20:23]
    ds_read_b128 v[40:43], v60 offset:49408
    v_mfma_f32_16x16x32_bf16 v[28:31], v[44:47], v[132:135], v[28:31]
    s_waitcnt lgkmcnt(5)
    v_mfma_f32_16x16x32_bf16 v[16:19], v[48:51], v[72:75], v[16:19]
    ds_read_b128 v[44:47], v61 offset:33024
    v_mfma_f32_16x16x32_bf16 v[24:27], v[48:51], v[136:139], v[24:27]
    s_waitcnt lgkmcnt(5)
    v_mfma_f32_16x16x32_bf16 v[20:23], v[52:55], v[72:75], v[20:23]
    ds_read_b128 v[48:51], v61 offset:49408
    v_mfma_f32_16x16x32_bf16 v[28:31], v[52:55], v[136:139], v[28:31]
    s_waitcnt lgkmcnt(5)
    v_mfma_f32_16x16x32_bf16 v[16:19], v[56:59], v[76:79], v[16:19]
    ds_read_b128 v[52:55], v62 offset:33024
    v_mfma_f32_16x16x32_bf16 v[24:27], v[56:59], v[140:143], v[24:27]
    s_waitcnt lgkmcnt(5)
    v_mfma_f32_16x16x32_bf16 v[20:23], v[32:35], v[76:79], v[20:23]
    ds_read_b128 v[56:59], v62 offset:49408
    v_mfma_f32_16x16x32_bf16 v[28:31], v[32:35], v[140:143], v[28:31]
    s_waitcnt lgkmcnt(5)
    v_mfma_f32_16x16x32_bf16 v[16:19], v[36:39], v[80:83], v[16:19]
    ds_read_b128 v[32:35], v63 offset:33024
    v_mfma_f32_16x16x32_bf16 v[24:27], v[36:39], v[144:147], v[24:27]
    s_waitcnt lgkmcnt(5)
    v_mfma_f32_16x16x32_bf16 v[20:23], v[40:43], v[80:83], v[20:23]
    ds_read_b128 v[36:39], v63 offset:49408
    v_mfma_f32_16x16x32_bf16 v[28:31], v[40:43], v[144:147], v[28:31]
    s_waitcnt lgkmcnt(5)
    v_mfma_f32_16x16x32_bf16 v[16:19], v[44:47], v[84:87], v[16:19]
    ds_read_b128 v[40:43], v60 offset:33280
    v_mfma_f32_16x16x32_bf16 v[24:27], v[44:47], v[148:151], v[24:27]
    s_waitcnt lgkmcnt(5)
    v_mfma_f32_16x16x32_bf16 v[20:23], v[48:51], v[84:87], v[20:23]
    ds_read_b128 v[44:47], v60 offset:49664
    v_mfma_f32_16x16x32_bf16 v[28:31], v[48:51], v[148:151], v[28:31]
    s_waitcnt lgkmcnt(5)
    v_mfma_f32_16x16x32_bf16 v[16:19], v[52:55], v[88:91], v[16:19]
    ds_read_b128 v[48:51], v61 offset:33280
    v_mfma_f32_16x16x32_bf16 v[24:27], v[52:55], v[152:155], v[24:27]
    s_waitcnt lgkmcnt(5)
    v_mfma_f32_16x16x32_bf16 v[20:23], v[56:59], v[88:91], v[20:23]
    ds_read_b128 v[52:55], v61 offset:49664
    v_mfma_f32_16x16x32_bf16 v[28:31], v[56:59], v[152:155], v[28:31]
    s_waitcnt lgkmcnt(5)
    v_mfma_f32_16x16x32_bf16 v[16:19], v[32:35], v[92:95], v[16:19]
    ds_read_b128 v[56:59], v62 offset:33280
    v_mfma_f32_16x16x32_bf16 v[24:27], v[32:35], v[156:159], v[24:27]
    s_waitcnt lgkmcnt(5)
    v_mfma_f32_16x16x32_bf16 v[20:23], v[36:39], v[92:95], v[20:23]
    ds_read_b128 v[32:35], v62 offset:49664
    v_mfma_f32_16x16x32_bf16 v[28:31], v[36:39], v[156:159], v[28:31]
    s_waitcnt lgkmcnt(5)
    v_mfma_f32_16x16x32_bf16 v[16:19], v[40:43], v[96:99], v[16:19]
    ds_read_b128 v[36:39], v63 offset:33280
    v_mfma_f32_16x16x32_bf16 v[24:27], v[40:43], v[160:163], v[24:27]
    s_waitcnt lgkmcnt(5)
    v_mfma_f32_16x16x32_bf16 v[20:23], v[44:47], v[96:99], v[20:23]
    ds_read_b128 v[40:43], v63 offset:49664
    v_mfma_f32_16x16x32_bf16 v[28:31], v[44:47], v[160:163], v[28:31]
    s_waitcnt lgkmcnt(5)
    v_mfma_f32_16x16x32_bf16 v[16:19], v[48:51], v[100:103], v[16:19]
    ds_read_b128 v[44:47], v60 offset:33536
    v_mfma_f32_16x16x32_bf16 v[24:27], v[48:51], v[164:167], v[24:27]
    s_waitcnt lgkmcnt(5)
    v_mfma_f32_16x16x32_bf16 v[20:23], v[52:55], v[100:103], v[20:23]
    ds_read_b128 v[48:51], v60 offset:49920
    v_mfma_f32_16x16x32_bf16 v[28:31], v[52:55], v[164:167], v[28:31]
    s_waitcnt lgkmcnt(5)
    v_mfma_f32_16x16x32_bf16 v[16:19], v[56:59], v[104:107], v[16:19]
    ds_read_b128 v[52:55], v61 offset:33536
    v_mfma_f32_16x16x32_bf16 v[24:27], v[56:59], v[168:171], v[24:27]
    s_waitcnt lgkmcnt(5)
    v_mfma_f32_16x16x32_bf16 v[20:23], v[32:35], v[104:107], v[20:23]
    ds_read_b128 v[56:59], v61 offset:49920
    v_mfma_f32_16x16x32_bf16 v[28:31], v[32:35], v[168:171], v[28:31]
    s_waitcnt lgkmcnt(5)
    v_mfma_f32_16x16x32_bf16 v[16:19], v[36:39], v[108:111], v[16:19]
    ds_read_b128 v[32:35], v62 offset:33536
    v_mfma_f32_16x16x32_bf16 v[24:27], v[36:39], v[172:175], v[24:27]
    s_waitcnt lgkmcnt(5)
    v_mfma_f32_16x16x32_bf16 v[20:23], v[40:43], v[108:111], v[20:23]
    ds_read_b128 v[36:39], v62 offset:49920
    v_mfma_f32_16x16x32_bf16 v[28:31], v[40:43], v[172:175], v[28:31]
    s_waitcnt lgkmcnt(5)
    v_mfma_f32_16x16x32_bf16 v[16:19], v[44:47], v[112:115], v[16:19]
    ds_read_b128 v[40:43], v63 offset:33536
    v_mfma_f32_16x16x32_bf16 v[24:27], v[44:47], v[176:179], v[24:27]
    s_waitcnt lgkmcnt(5)
    v_mfma_f32_16x16x32_bf16 v[20:23], v[48:51], v[112:115], v[20:23]
    ds_read_b128 v[44:47], v63 offset:49920
    v_mfma_f32_16x16x32_bf16 v[28:31], v[48:51], v[176:179], v[28:31]
    s_waitcnt lgkmcnt(5)
    v_mfma_f32_16x16x32_bf16 v[16:19], v[52:55], v[116:119], v[16:19]
    v_mfma_f32_16x16x32_bf16 v[24:27], v[52:55], v[180:183], v[24:27]
    s_waitcnt lgkmcnt(4)
    v_mfma_f32_16x16x32_bf16 v[20:23], v[56:59], v[116:119], v[20:23]
    v_mfma_f32_16x16x32_bf16 v[28:31], v[56:59], v[180:183], v[28:31]
    s_waitcnt lgkmcnt(3)
    v_mfma_f32_16x16x32_bf16 v[16:19], v[32:35], v[120:123], v[16:19]
    v_mfma_f32_16x16x32_bf16 v[24:27], v[32:35], v[184:187], v[24:27]
    s_waitcnt lgkmcnt(2)
    v_mfma_f32_16x16x32_bf16 v[20:23], v[36:39], v[120:123], v[20:23]
    v_mfma_f32_16x16x32_bf16 v[28:31], v[36:39], v[184:187], v[28:31]
    s_waitcnt lgkmcnt(1)
    v_mfma_f32_16x16x32_bf16 v[16:19], v[40:43], v[124:127], v[16:19]
    v_mfma_f32_16x16x32_bf16 v[24:27], v[40:43], v[188:191], v[24:27]
    s_waitcnt lgkmcnt(0)
    v_mfma_f32_16x16x32_bf16 v[20:23], v[44:47], v[124:127], v[20:23]
    v_mfma_f32_16x16x32_bf16 v[28:31], v[44:47], v[188:191], v[28:31]
    s_nop 3
    s_nop 0
    v_cvt_pk_bf16_f32 v16, v16, v17
    v_cvt_pk_bf16_f32 v17, v18, v19
    ds_write_b64 v9, v[16:17] offset:0
    v_cvt_pk_bf16_f32 v20, v20, v21
    v_cvt_pk_bf16_f32 v21, v22, v23
    ds_write_b64 v9, v[20:21] offset:512
    v_cvt_pk_bf16_f32 v24, v24, v25
    v_cvt_pk_bf16_f32 v25, v26, v27
    ds_write_b64 v9, v[24:25] offset:1024
    v_cvt_pk_bf16_f32 v28, v28, v29
    v_cvt_pk_bf16_f32 v29, v30, v31
    ds_write_b64 v9, v[28:29] offset:1536
    s_waitcnt lgkmcnt(0)
    ds_read_b128 v[40:43], v10
    ds_read_b128 v[44:47], v10 offset:1024
fin_12:
    v_lshrrev_b32 v4, 1, v14
    v_lshlrev_b32 v4, 4, v4
    v_and_b32 v5, 1, v14
    v_lshl_or_b32 v4, v5, 2, v4
    v_bfe_u32 v5, v1, 2, 2
    v_add_u32 v4, v4, v5
    v_lshlrev_b32 v4, 5, v4
    v_and_b32_e64 v5, 3, v1
    v_lshl_or_b32 v4, v5, 3, v4
    v_add_u32_e64 v4, s48, v4
    ds_read_b64_tr_b16 v[48:49], v4
    ds_read_b64_tr_b16 v[50:51], v4 offset:256
    s_lshl_b32 s31, s3, 4
    s_add_u32 s31, s31, s51
    s_lshl_b32 s31, s31, 10
    s_add_u32 s31, s31, 12058624
    s_cmp_ge_u32 s24, 6
    s_cselect_b32 s31, 0x7ff00000, s31
    s_add_u32 s37, s50, 33882112
    v_mov_b32 v52, s36
    v_mov_b32_e64 v53, 0
    s_waitcnt lgkmcnt(0)
    buffer_store_dwordx4 v[40:43], v6, s[8:11], s35 offen sc1
    buffer_store_dwordx4 v[44:47], v6, s[8:11], s49 offen sc1
    buffer_store_dwordx4 v[48:51], v6, s[8:11], s31 offen sc1
iend_5:
    s_mov_b32 s20, s62
    s_and_b32 s21, s63, 0xffff
    s_mov_b32 s22, 2097152
    s_mov_b32 s23, 0x20000
    s_and_b32 s28, s2, 6
    s_lshl_b32 s28, s28, 1
    s_lshr_b32 s29, s2, 6
    s_add_u32 s28, s28, s29
    s_bfe_u32 s29, s2, 0x30003
    s_and_b32 s32, s2, 1
    s_lshl_b32 s32, s32, 3
    s_add_u32 s29, s29, s32
    s_lshl_b32 s27, s28, 2
    s_lshr_b32 s56, s29, 2
    s_add_u32 s56, s56, s27
    s_and_b32 s57, s29, 3
    s_add_u32 s27, s27, s25
    s_mov_b32 s50, 0
    s_mov_b32 s51, 2097152
    s_mov_b32 s52, 8388608
    s_mov_b32 s53, 16777216
    s_mov_b32 s54, 25165824
    s_mov_b32 s55, 0
    s_mov_b32 s58, 131072
    s_sub_u32 s32, 3, s25
    s_cmp_ge_u32 s24, 4
    s_cselect_b32 s63, s32, s25
    s_lshl_b32 s3, s28, 2
    s_add_u32 s3, s3, s63
    s_lshl_b32 s40, s63, 13
    s_add_u32 s40, s40, 98304
    s_lshl_b32 s32, s28, 2
    s_sub_i32 s32, 8, s32
    s_max_i32 s32, s32, s63
    s_sub_u32 s41, 8, s32
    s_lshl_b32 s42, s32, 12
    s_add_u32 s42, s42, 131072
    s_lshr_b32 s33, s24, 1
    s_lshl_b32 s33, s33, 13
    s_and_b32 s34, s24, 1
    s_lshl_b32 s34, s34, 10
    s_add_u32 s61, s33, s34
    s_add_u32 s61, s61, 104448
    s_movk_i32 s49, 0x207
    s_mov_b32 s62, 1
    s_cmp_ge_u32 s24, 4
    s_cbranch_scc1 h0_13
    v_lshlrev_b32 v4, 6, v1
    v_mov_b32 v15, v4
    s_lshl_b32 s33, s24, 12
    s_add_u32 s33, s33, 33816576
    s_cmp_eq_u32 s62, 0
    s_cbranch_scc1 n1_14
    s_mov_b32 s62, 0
    s_call_b64 s[6:7], GEN_MAT
    s_call_b64 s[6:7], GEN_TW
    v_lshlrev_b32 v4, 2, v3
    v_sub_u32 v4, v2, v4
    v_cvt_f32_i32 v4, v4
    v_mul_f32 v4, 0x71800000, v4
    v_subrev_f32 v96, 0x00000000, v4
    v_min_f32 v96, 0, v96
    v_subrev_f32 v97, 0x71800000, v4
    v_min_f32_e64 v97, 0, v97
    v_subrev_f32 v98, 0x72000000, v4
    v_min_f32_e64 v98, 0, v98
    v_subrev_f32 v99, 0x72400000, v4
    v_min_f32_e64 v99, 0, v99
    v_subrev_f32 v100, 0x73000000, v4
    v_min_f32_e64 v100, 0, v100
    v_subrev_f32 v101, 0x73100000, v4
    v_min_f32_e64 v101, 0, v101
    v_subrev_f32 v102, 0x73200000, v4
    v_min_f32_e64 v102, 0, v102
    v_subrev_f32 v103, 0x73300000, v4
    v_min_f32_e64 v103, 0, v103
    v_subrev_f32 v104, 0x73800000, v4
    v_min_f32_e64 v104, 0, v104
    v_subrev_f32 v105, 0x73880000, v4
    v_min_f32_e64 v105, 0, v105
    v_subrev_f32 v106, 0x73900000, v4
    v_min_f32_e64 v106, 0, v106
    v_subrev_f32 v107, 0x73980000, v4
    v_min_f32_e64 v107, 0, v107
    v_subrev_f32 v108, 0x73c00000, v4
    v_min_f32_e64 v108, 0, v108
    v_subrev_f32 v109, 0x73c80000, v4
    v_min_f32_e64 v109, 0, v109
    v_subrev_f32 v110, 0x73d00000, v4
    v_min_f32_e64 v110, 0, v110
    v_subrev_f32 v111, 0x73d80000, v4
    v_min_f32_e64 v111, 0, v111
n1_14:
fpoll_15:
    buffer_load_dword v5, v15, s[8:11], s33 offen sc1
    s_waitcnt vmcnt(0)
    v_cmp_ne_u32 vcc, s36, v5
    s_nop 0
    s_cbranch_vccz px_16
    s_sub_u32 s58, s58, 1
    s_cbranch_scc0 fpoll_15
    s_mov_b32 s58, 0
px_16:
    s_lshl_b32 s30, s2, 13
    s_lshl_b32 s31, s24, 11
    s_add_u32 s30, s30, s31
    s_add_u32 s30, s30, 12582912
    buffer_load_dwordx4 v[88:91], v6, s[8:11], s30 offen sc1
    buffer_load_dwordx4 v[92:95], v6, s[8:11], s30 offen offset:1024 sc1
h0_13:
layer_17:
    s_cmp_ge_u32 s24, 4
    s_cbranch_scc1 helper_18
    v_lshrrev_b32 v4, 2, v0
    v_and_b32 v7, 3, v0
    v_lshlrev_b32_e64 v7, 4, v7
    v_lshl_or_b32 v7, v4, 15, v7
    v_lshlrev_b32_e64 v12, 5, v0
    s_lshl_b32 s33, s2, 7
    s_add_u32 s35, s33, s50
    v_mov_b32 v10, 0x3b000000
    v_mov_b32 v11, 0x3b000000
    v_mov_b32 v8, 0x3727c5ac
    v_mov_b32 v9, 0x3727c5ac
cheavy_22:
    buffer_load_dwordx4 v[64:67], v7, s[8:11], s35 offen sc1
    buffer_load_dwordx4 v[68:71], v7, s[8:11], s35 offen offset:64 sc1
    s_add_u32 s34, s52, 0
    s_nop 0
    buffer_load_dwordx4 v[32:35], v12, s[8:11], s34 offen sc1
    buffer_load_dwordx4 v[36:39], v12, s[8:11], s34 offen offset:16 sc1
    s_add_u32 s34, s52, 8192
    buffer_load_dwordx4 v[40:43], v12, s[8:11], s34 offen sc1
    buffer_load_dwordx4 v[44:47], v12, s[8:11], s34 offen offset:16 sc1
    s_add_u32 s34, s52, 16384
    buffer_load_dwordx4 v[48:51], v12, s[8:11], s34 offen sc1
    buffer_load_dwordx4 v[52:55], v12, s[8:11], s34 offen offset:16 sc1
    s_add_u32 s34, s52, 24576
    buffer_load_dwordx4 v[56:59], v12, s[8:11], s34 offen sc1
    buffer_load_dwordx4 v[60:63], v12, s[8:11], s34 offen offset:16 sc1
    s_cmp_eq_u32 s62, 0
    s_cbranch_scc1 nfirst_23
    s_mov_b32 s62, 0
    s_call_b64 s[6:7], GEN_MAT
nfirst_23:
    s_waitcnt vmcnt(0)
    s_nop 0
    v_pk_add_f32 v[32:33], v[32:33], v[40:41]
    v_pk_add_f32 v[48:49], v[48:49], v[56:57]
    v_pk_add_f32 v[34:35], v[34:35], v[42:43]
    v_pk_add_f32 v[50:51], v[50:51], v[58:59]
    v_pk_add_f32 v[36:37], v[36:37], v[44:45]
    v_pk_add_f32 v[52:53], v[52:53], v[60:61]
    v_pk_add_f32 v[38:39], v[38:39], v[46:47]
    v_pk_add_f32 v[54:55], v[54:55], v[62:63]
    v_max3_u32 v4, v64, v65, v66
    v_max3_u32 v5, v67, v68, v69
    v_pk_add_f32 v[32:33], v[32:33], v[48:49]
    v_pk_add_f32 v[34:35], v[34:35], v[50:51]
    v_pk_add_f32 v[36:37], v[36:37], v[52:53]
    v_pk_add_f32 v[38:39], v[38:39], v[54:55]
    v_max3_u32 v4, v70, v71, v4
    v_pk_add_f32 v[40:41], v[32:33], v[34:35]
    v_pk_add_f32 v[42:43], v[36:37], v[38:39]
    v_max_u32_e64 v4, v4, v5
    v_pk_add_f32 v[40:41], v[40:41], v[42:43]
    v_cmp_eq_u32 s[4:5], -1, v4
    v_cmp_u_f32 vcc, v40, v41
    v_pk_fma_f32 v[32:33], v[32:33], v[10:11], v[8:9]
    v_pk_fma_f32 v[34:35], v[34:35], v[10:11], v[8:9]
    v_pk_fma_f32 v[36:37], v[36:37], v[10:11], v[8:9]
    v_pk_fma_f32 v[38:39], v[38:39], v[10:11], v[8:9]
    s_or_b64 vcc, vcc, s[4:5]
    s_cbranch_vccz px_24
    s_sub_u32 s58, s58, 1
    s_cbranch_scc0 cheavy_22
    s_mov_b32 s58, 0
px_24:
    v_rsq_f32 v32, v32
    v_rsq_f32 v33, v33
    v_rsq_f32 v34, v34
    v_rsq_f32 v35, v35
    v_rsq_f32 v36, v36
    v_rsq_f32 v37, v37
    v_rsq_f32 v38, v38
    v_rsq_f32 v39, v39
    v_lshlrev_b32_e64 v7, 4, v0
    v_add_u32 v7, 131072, v7
    ds_write_b128 v7, v[64:67] offset:8192
    ds_write_b128 v7, v[68:71] offset:12288
    s_cmp_lg_u32 s2, 0
    s_cbranch_scc1 jnz_25
    v_mov_b32 v64, v68
    v_mov_b32 v65, v69
    v_mov_b32 v66, v70
    v_mov_b32 v67, v71
    v_mov_b32 v68, 0
    v_mov_b32 v69, 0
    v_mov_b32 v70, 0
    v_mov_b32 v71, 0
jnz_25:
    v_lshlrev_b32_e64 v40, 16, v64
    v_and_b32 v41, 0xffff0000, v64
    v_pk_mul_f32 v[40:41], v[40:41], v[32:33]
    v_cvt_pk_bf16_f32 v48, v40, v41
    v_lshlrev_b32_e64 v42, 16, v65
    v_and_b32 v43, 0xffff0000, v65
    v_pk_mul_f32 v[42:43], v[42:43], v[34:35]
    v_cvt_pk_bf16_f32 v49, v42, v43
    v_lshlrev_b32_e64 v44, 16, v66
    v_and_b32 v45, 0xffff0000, v66
    v_pk_mul_f32 v[44:45], v[44:45], v[36:37]
    v_cvt_pk_bf16_f32 v50, v44, v45
    v_lshlrev_b32_e64 v46, 16, v67
    v_and_b32 v47, 0xffff0000, v67
    v_pk_mul_f32 v[46:47], v[46:47], v[38:39]
    v_cvt_pk_bf16_f32 v51, v46, v47
    ds_write_b128 v7, v[48:51] offset:0
    v_lshlrev_b32_e64 v40, 16, v68
    v_and_b32 v41, 0xffff0000, v68
    v_pk_mul_f32 v[40:41], v[40:41], v[32:33]
    v_cvt_pk_bf16_f32 v52, v40, v41
    v_lshlrev_b32_e64 v42, 16, v69
    v_and_b32 v43, 0xffff0000, v69
    v_pk_mul_f32 v[42:43], v[42:43], v[34:35]
    v_cvt_pk_bf16_f32 v53, v42, v43
    v_lshlrev_b32_e64 v44, 16, v70
    v_and_b32 v45, 0xffff0000, v70
    v_pk_mul_f32 v[44:45], v[44:45], v[36:37]
    v_cvt_pk_bf16_f32 v54, v44, v45
    v_lshlrev_b32_e64 v46, 16, v71
    v_and_b32 v47, 0xffff0000, v71
    v_pk_mul_f32 v[46:47], v[46:47], v[38:39]
    v_cvt_pk_bf16_f32 v55, v46, v47
    ds_write_b128 v7, v[52:55] offset:4096
    s_waitcnt lgkmcnt(0)
    s_barrier
    v_bfe_u32 v4, v1, 2, 2
    v_lshl_add_u32 v4, v14, 3, v4
    v_lshlrev_b32 v4, 6, v4
    v_and_b32 v5, 3, v1
    v_lshl_or_b32 v4, v5, 3, v4
    v_add_u32 v4, 131072, v4
    ds_read_b64_tr_b16 v[32:33], v4 offset:0
    ds_read_b64_tr_b16 v[34:35], v4 offset:256
    ds_read_b64_tr_b16 v[48:49], v4 offset:4096
    ds_read_b64_tr_b16 v[50:51], v4 offset:4352
    ds_read_b64_tr_b16 v[36:37], v4 offset:2048
    ds_read_b64_tr_b16 v[38:39], v4 offset:2304
    ds_read_b64_tr_b16 v[52:53], v4 offset:6144
    ds_read_b64_tr_b16 v[54:55], v4 offset:6400
    ds_read_b64_tr_b16 v[40:41], v4 offset:32
    ds_read_b64_tr_b16 v[42:43], v4 offset:288
    ds_read_b64_tr_b16 v[56:57], v4 offset:4128
    ds_read_b64_tr_b16 v[58:59], v4 offset:4384
    ds_read_b64_tr_b16 v[44:45], v4 offset:2080
    ds_read_b64_tr_b16 v[46:47], v4 offset:2336
    ds_read_b64_tr_b16 v[60:61], v4 offset:6176
    ds_read_b64_tr_b16 v[62:63], v4 offset:6432
    v_xor_b32 v16, 0x80008000, v136
    v_xor_b32 v17, 0x80008000, v137
    v_xor_b32 v18, 0x80008000, v138
    v_xor_b32 v19, 0x80008000, v139
    v_xor_b32 v20, 0x80008000, v140
    v_xor_b32 v21, 0x80008000, v141
    v_xor_b32 v22, 0x80008000, v142
    v_xor_b32 v23, 0x80008000, v143
    s_waitcnt lgkmcnt(12)
    s_nop 0
    v_mfma_f32_16x16x32_bf16 v[64:67], v[32:35], v[128:131], 0
    v_xor_b32 v24, 0x80008000, v152
    v_xor_b32 v25, 0x80008000, v153
    v_mfma_f32_16x16x32_bf16 v[72:75], v[48:51], v[128:131], 0
    v_xor_b32 v26, 0x80008000, v154
    v_xor_b32 v27, 0x80008000, v155
    v_mfma_f32_16x16x32_bf16 v[64:67], v[48:51], v[136:139], v[64:67]
    v_xor_b32 v28, 0x80008000, v156
    v_xor_b32 v29, 0x80008000, v157
    v_mfma_f32_16x16x32_bf16 v[72:75], v[32:35], v[16:19], v[72:75]
    v_xor_b32 v30, 0x80008000, v158
    v_xor_b32 v31, 0x80008000, v159
    s_waitcnt lgkmcnt(8)
    v_mfma_f32_16x16x32_bf16 v[64:67], v[36:39], v[132:135], v[64:67]
    v_mul_u32_u24 v4, 144, v13
    v_lshl_add_u32 v4, v14, 3, v4
    v_mfma_f32_16x16x32_bf16 v[72:75], v[52:55], v[132:135], v[72:75]
    s_lshl_b32 s31, s24, 5
    s_add_u32 s31, s31, 147456
    v_mfma_f32_16x16x32_bf16 v[64:67], v[52:55], v[140:143], v[64:67]
    v_add_u32 v4, s31, v4
    v_lshrrev_b32 v5, 2, v13
    v_mfma_f32_16x16x32_bf16 v[72:75], v[36:39], v[20:23], v[72:75]
    v_lshlrev_b32_e64 v5, 3, v5
    v_and_or_b32 v5, v13, 3, v5
    s_waitcnt lgkmcnt(4)
    v_mfma_f32_16x16x32_bf16 v[68:71], v[40:43], v[128:131], 0
    v_mul_u32_u24 v5, 144, v5
    v_lshl_add_u32 v5, v14, 4, v5
    v_mfma_f32_16x16x32_bf16 v[76:79], v[56:59], v[128:131], 0
    v_add_u32 v5, 147456, v5
    v_lshlrev_b32 v7, 6, v13
    v_mfma_f32_16x16x32_bf16 v[68:71], v[56:59], v[136:139], v[68:71]
    v_lshl_or_b32 v7, v14, 4, v7
    s_lshl_b32 s31, s24, 10
    v_mfma_f32_16x16x32_bf16 v[76:79], v[40:43], v[16:19], v[76:79]
    v_add_u32 v7, s31, v7
    v_add_u32 v12, 139264, v7
    s_waitcnt lgkmcnt(0)
    v_mfma_f32_16x16x32_bf16 v[68:71], v[44:47], v[132:135], v[68:71]
    v_lshlrev_b32 v7, 15, v13
    v_lshl_or_b32 v7, v14, 4, v7
    v_mfma_f32_16x16x32_bf16 v[76:79], v[60:63], v[132:135], v[76:79]
    v_mfma_f32_16x16x32_bf16 v[68:71], v[60:63], v[140:143], v[68:71]
    v_mfma_f32_16x16x32_bf16 v[76:79], v[44:47], v[20:23], v[76:79]
    v_pk_mul_f32 v[192:193], v[64:65], v[160:161]
    v_pk_mul_f32 v[200:201], v[72:73], v[160:161]
    v_pk_fma_f32 v[192:193], v[72:73], v[168:169], v[192:193]
    v_pk_fma_f32 v[200:201], v[64:65], v[168:169], v[200:201] neg_lo:[1,0,0] neg_hi:[1,0,0]
    v_pk_mul_f32 v[194:195], v[66:67], v[162:163]
    v_pk_mul_f32 v[202:203], v[74:75], v[162:163]
    v_pk_fma_f32 v[194:195], v[74:75], v[170:171], v[194:195]
    v_pk_fma_f32 v[202:203], v[66:67], v[170:171], v[202:203] neg_lo:[1,0,0] neg_hi:[1,0,0]
    v_pk_mul_f32 v[196:197], v[68:69], v[164:165]
    v_pk_mul_f32 v[204:205], v[76:77], v[164:165]
    v_pk_fma_f32 v[196:197], v[76:77], v[172:173], v[196:197]
    v_pk_fma_f32 v[204:205], v[68:69], v[172:173], v[204:205] neg_lo:[1,0,0] neg_hi:[1,0,0]
    v_pk_mul_f32 v[198:199], v[70:71], v[166:167]
    v_pk_mul_f32 v[206:207], v[78:79], v[166:167]
    v_pk_fma_f32 v[198:199], v[78:79], v[174:175], v[198:199]
    v_pk_fma_f32 v[206:207], v[70:71], v[174:175], v[206:207] neg_lo:[1,0,0] neg_hi:[1,0,0]
    v_cvt_pk_bf16_f32 v80, v192, v193
    v_cvt_pk_bf16_f32 v81, v194, v195
    v_cvt_pk_bf16_f32 v82, v196, v197
    v_cvt_pk_bf16_f32 v83, v198, v199
    v_cvt_pk_bf16_f32 v84, v200, v201
    v_cvt_pk_bf16_f32 v85, v202, v203
    v_cvt_pk_bf16_f32 v86, v204, v205
    v_cvt_pk_bf16_f32 v87, v206, v207
    v_mfma_f32_16x16x32_bf16 v[64:67], v[144:147], v[80:83], 0
    v_lshlrev_b32_e64 v32, 16, v88
    v_and_b32 v40, 0xffff0000, v88
    v_mfma_f32_16x16x32_bf16 v[72:75], v[144:147], v[84:87], 0
    v_lshlrev_b32_e64 v33, 16, v89
    v_and_b32 v41, 0xffff0000, v89
    v_mfma_f32_16x16x32_bf16 v[68:71], v[148:151], v[80:83], 0
    v_lshlrev_b32_e64 v34, 16, v90
    v_and_b32 v42, 0xffff0000, v90
    v_mfma_f32_16x16x32_bf16 v[76:79], v[148:151], v[84:87], 0
    v_lshlrev_b32_e64 v35, 16, v91
    v_and_b32 v43, 0xffff0000, v91
    v_mfma_f32_16x16x32_bf16 v[64:67], v[152:155], v[84:87], v[64:67]
    v_lshlrev_b32_e64 v36, 16, v92
    v_and_b32 v44, 0xffff0000, v92
    v_mfma_f32_16x16x32_bf16 v[72:75], v[24:27], v[80:83], v[72:75]
    v_lshlrev_b32_e64 v37, 16, v93
    v_and_b32 v45, 0xffff0000, v93
    v_mfma_f32_16x16x32_bf16 v[68:71], v[156:159], v[84:87], v[68:71]
    v_lshlrev_b32_e64 v38, 16, v94
    v_and_b32 v46, 0xffff0000, v94
    v_mfma_f32_16x16x32_bf16 v[76:79], v[28:31], v[80:83], v[76:79]
    v_lshlrev_b32_e64 v39, 16, v95
    v_and_b32 v47, 0xffff0000, v95
    v_pk_mul_f32 v[192:193], v[64:65], v[32:33]
    v_pk_mul_f32 v[200:201], v[72:73], v[32:33]
    v_pk_fma_f32 v[192:193], v[72:73], v[40:41], v[192:193] neg_lo:[1,0,0] neg_hi:[1,0,0]
    v_pk_fma_f32 v[200:201], v[64:65], v[40:41], v[200:201]
    v_pk_mul_f32 v[194:195], v[66:67], v[34:35]
    v_pk_mul_f32 v[202:203], v[74:75], v[34:35]
    v_pk_fma_f32 v[194:195], v[74:75], v[42:43], v[194:195] neg_lo:[1,0,0] neg_hi:[1,0,0]
    v_pk_fma_f32 v[202:203], v[66:67], v[42:43], v[202:203]
    v_pk_mul_f32 v[196:197], v[68:69], v[36:37]
    v_pk_mul_f32 v[204:205], v[76:77], v[36:37]
    v_pk_fma_f32 v[196:197], v[76:77], v[44:45], v[196:197] neg_lo:[1,0,0] neg_hi:[1,0,0]
    v_pk_fma_f32 v[204:205], v[68:69], v[44:45], v[204:205]
    v_pk_mul_f32 v[198:199], v[70:71], v[38:39]
    v_pk_mul_f32 v[206:207], v[78:79], v[38:39]
    v_pk_fma_f32 v[198:199], v[78:79], v[46:47], v[198:199] neg_lo:[1,0,0] neg_hi:[1,0,0]
    v_pk_fma_f32 v[206:207], v[70:71], v[46:47], v[206:207]
    v_cvt_pk_bf16_f32 v80, v192, v193
    v_cvt_pk_bf16_f32 v81, v194, v195
    v_cvt_pk_bf16_f32 v82, v196, v197
    v_cvt_pk_bf16_f32 v83, v198, v199
    v_cvt_pk_bf16_f32 v84, v200, v201
    v_cvt_pk_bf16_f32 v85, v202, v203
    v_cvt_pk_bf16_f32 v86, v204, v205
    v_cvt_pk_bf16_f32 v87, v206, v207
    v_mfma_f32_16x16x32_bf16 v[64:67], v[80:83], v[144:147], 0
    s_nop 0
    s_nop 0
    v_mfma_f32_16x16x32_bf16 v[72:75], v[84:87], v[144:147], 0
    v_mfma_f32_16x16x32_bf16 v[68:71], v[80:83], v[148:151], 0
    v_mfma_f32_16x16x32_bf16 v[76:79], v[84:87], v[148:151], 0
    ds_read_b128 v[8:11], v12
    ds_read_b128 v[88:91], v12 offset:4096
    v_mfma_f32_16x16x32_bf16 v[64:67], v[84:87], v[24:27], v[64:67]
    v_mfma_f32_16x16x32_bf16 v[72:75], v[80:83], v[152:155], v[72:75]
    v_mfma_f32_16x16x32_bf16 v[68:71], v[84:87], v[28:31], v[68:71]
    v_mfma_f32_16x16x32_bf16 v[76:79], v[80:83], v[156:159], v[76:79]
    s_nop 4
    s_nop 0
    v_pk_mul_f32 v[192:193], v[64:65], v[176:177]
    v_pk_mul_f32 v[200:201], v[72:73], v[176:177]
    v_pk_fma_f32 v[192:193], v[72:73], v[184:185], v[192:193] neg_lo:[1,0,0] neg_hi:[1,0,0]
    v_pk_fma_f32 v[200:201], v[64:65], v[184:185], v[200:201]
    v_pk_mul_f32 v[194:195], v[66:67], v[178:179]
    v_pk_mul_f32 v[202:203], v[74:75], v[178:179]
    v_pk_fma_f32 v[194:195], v[74:75], v[186:187], v[194:195] neg_lo:[1,0,0] neg_hi:[1,0,0]
    v_pk_fma_f32 v[202:203], v[66:67], v[186:187], v[202:203]
    v_pk_mul_f32 v[196:197], v[68:69], v[180:181]
    v_pk_mul_f32 v[204:205], v[76:77], v[180:181]
    v_pk_fma_f32 v[196:197], v[76:77], v[188:189], v[196:197] neg_lo:[1,0,0] neg_hi:[1,0,0]
    v_pk_fma_f32 v[204:205], v[68:69], v[188:189], v[204:205]
    v_pk_mul_f32 v[198:199], v[70:71], v[182:183]
    v_pk_mul_f32 v[206:207], v[78:79], v[182:183]
    v_pk_fma_f32 v[198:199], v[78:79], v[190:191], v[198:199] neg_lo:[1,0,0] neg_hi:[1,0,0]
    v_pk_fma_f32 v[206:207], v[70:71], v[190:191], v[206:207]
    v_cvt_pk_bf16_f32 v80, v192, v193
    v_cvt_pk_bf16_f32 v81, v194, v195
    v_cvt_pk_bf16_f32 v82, v196, v197
    v_cvt_pk_bf16_f32 v83, v198, v199
    v_cvt_pk_bf16_f32 v84, v200, v201
    v_cvt_pk_bf16_f32 v85, v202, v203
    v_cvt_pk_bf16_f32 v86, v204, v205
    v_cvt_pk_bf16_f32 v87, v206, v207
    ds_write_b64 v4, v[80:81] offset:0
    ds_write_b64 v4, v[82:83] offset:2304
    ds_write_b64 v4, v[84:85] offset:8192
    ds_write_b64 v4, v[86:87] offset:10496
    s_waitcnt lgkmcnt(0)
    s_barrier
    ds_read_b128 v[32:35], v5 offset:0
    ds_read_b128 v[48:51], v5 offset:8192
    ds_read_b128 v[36:39], v5 offset:64
    ds_read_b128 v[52:55], v5 offset:8256
    ds_read_b128 v[40:43], v5 offset:576
    ds_read_b128 v[56:59], v5 offset:8768
    ds_read_b128 v[44:47], v5 offset:640
    ds_read_b128 v[60:63], v5 offset:8832
    s_waitcnt lgkmcnt(6)
    v_mfma_f32_16x16x32_bf16 v[64:67], v[32:35], v[128:131], 0
    v_lshlrev_b32 v192, 16, v8
    v_and_b32 v193, 0xffff0000, v8
    v_mfma_f32_16x16x32_bf16 v[72:75], v[48:51], v[128:131], 0
    v_lshlrev_b32_e64 v194, 16, v9
    v_and_b32 v195, 0xffff0000, v9
    v_mfma_f32_16x16x32_bf16 v[64:67], v[48:51], v[16:19], v[64:67]
    v_lshlrev_b32_e64 v196, 16, v10
    v_and_b32 v197, 0xffff0000, v10
    v_mfma_f32_16x16x32_bf16 v[72:75], v[32:35], v[136:139], v[72:75]
    v_lshlrev_b32_e64 v198, 16, v11
    v_and_b32 v199, 0xffff0000, v11
    s_waitcnt lgkmcnt(4)
    v_mfma_f32_16x16x32_bf16 v[64:67], v[36:39], v[132:135], v[64:67]
    v_lshlrev_b32 v200, 16, v88
    v_and_b32 v201, 0xffff0000, v88
    v_mfma_f32_16x16x32_bf16 v[72:75], v[52:55], v[132:135], v[72:75]
    v_lshlrev_b32_e64 v202, 16, v89
    v_and_b32 v203, 0xffff0000, v89
    v_mfma_f32_16x16x32_bf16 v[64:67], v[52:55], v[20:23], v[64:67]
    v_lshlrev_b32_e64 v204, 16, v90
    v_and_b32 v205, 0xffff0000, v90
    v_mfma_f32_16x16x32_bf16 v[72:75], v[36:39], v[140:143], v[72:75]
    v_lshlrev_b32_e64 v206, 16, v91
    v_and_b32 v207, 0xffff0000, v91
    s_waitcnt lgkmcnt(2)
    v_mfma_f32_16x16x32_bf16 v[68:71], v[40:43], v[128:131], 0
    v_mfma_f32_16x16x32_bf16 v[76:79], v[56:59], v[128:131], 0
    v_mfma_f32_16x16x32_bf16 v[68:71], v[56:59], v[16:19], v[68:71]
    v_mfma_f32_16x16x32_bf16 v[76:79], v[40:43], v[136:139], v[76:79]
    s_waitcnt lgkmcnt(0)
    v_mfma_f32_16x16x32_bf16 v[68:71], v[44:47], v[132:135], v[68:71]
    v_mfma_f32_16x16x32_bf16 v[76:79], v[60:63], v[132:135], v[76:79]
    v_mfma_f32_16x16x32_bf16 v[68:71], v[60:63], v[20:23], v[68:71]
    v_mfma_f32_16x16x32_bf16 v[76:79], v[44:47], v[140:143], v[76:79]
    s_cmp_lg_u32 s2, 0
    s_cbranch_scc1 jnz_26
    v_mov_b32 v72, v64
    v_mov_b32 v73, v65
    v_mov_b32 v74, v66
    v_mov_b32 v75, v67
    s_nop 1
    v_mov_b32 v76, v68
    v_mov_b32 v77, v69
    v_mov_b32 v78, v70
    v_mov_b32 v79, v71
    v_mov_b32 v64, 0
    v_mov_b32 v65, 0
    v_mov_b32 v66, 0
    v_mov_b32 v67, 0
    v_mov_b32 v68, 0
    v_mov_b32 v69, 0
    v_mov_b32 v70, 0
    v_mov_b32_e64 v71, 0
jnz_26:
    s_lshl_b32 s31, s2, 7
    s_lshl_b32 s32, s24, 19
    s_add_u32 s31, s31, s32
    s_add_u32 s31, s31, s51
    v_pk_add_f32 v[192:193], v[192:193], v[64:65]
    v_cvt_pk_bf16_f32 v80, v192, v193
    v_pk_add_f32 v[194:195], v[194:195], v[66:67]
    v_cvt_pk_bf16_f32 v81, v194, v195
    v_pk_add_f32 v[196:197], v[196:197], v[68:69]
    v_cvt_pk_bf16_f32 v82, v196, v197
    v_pk_add_f32 v[198:199], v[198:199], v[70:71]
    v_cvt_pk_bf16_f32 v83, v198, v199
    buffer_store_dwordx4 v[80:83], v7, s[8:11], s31 offen offset:0 sc1
    v_pk_add_f32 v[200:201], v[200:201], v[72:73]
    v_cvt_pk_bf16_f32 v84, v200, v201
    v_pk_add_f32 v[202:203], v[202:203], v[74:75]
    v_cvt_pk_bf16_f32 v85, v202, v203
    v_pk_add_f32 v[204:205], v[204:205], v[76:77]
    v_cvt_pk_bf16_f32 v86, v204, v205
    v_pk_add_f32 v[206:207], v[206:207], v[78:79]
    v_cvt_pk_bf16_f32 v87, v206, v207
    buffer_store_dwordx4 v[84:87], v7, s[8:11], s31 offen offset:64 sc1
    s_lshl_b32 s31, s24, 14
    s_add_u32 s31, s31, 98304
    v_bfe_u32 v8, v1, 2, 2
    v_lshl_add_u32 v8, v14, 2, v8
    v_lshlrev_b32 v8, 6, v8
    v_and_b32_e64 v4, 1, v14
    v_lshl_or_b32 v8, v4, 5, v8
    v_and_b32_e64 v4, 3, v1
    v_lshl_or_b32 v8, v4, 3, v8
    v_add_u32 v8, s31, v8
    v_xor_b32 v10, 32, v8
    v_min_u32 v9, 1, v14
    v_lshlrev_b32_e64 v4, 16, v9
    v_sub_u32 v9, v4, v9
    v_or_b32 v9, 0xffff0000, v9
    v_add_u32 v5, 65536, v6
    s_lshl_b32 s33, s24, 13
    s_add_u32 s33, s33, 32768
    v_subrev_u32 v16, s33, v8
    v_subrev_u32 v17, s33, v10
    s_lshl_b32 s32, s29, 6
    s_add_u32 s32, s32, s27
    s_lshl_b32 s32, s32, 12
    s_add_u32 s32, s32, s53
    v_add_u32 v7, s40, v6
    v_lshl_add_u32 v15, v13, 2, s31
    v_lshl_add_u32 v11, v14, 4, s31
    s_lshl_b32 s33, s28, 4
    s_add_u32 s33, s33, s29
    s_lshl_b32 s33, s33, 9
    s_lshl_b32 s34, s24, 6
    s_add_u32 s33, s33, s34
    s_lshl_b32 s34, s55, 17
    s_add_u32 s33, s33, s34
    s_add_u32 s44, s33, 33562880
    v_add_u32_e64 v4, s28, v1
    v_cmp_gt_u32 vcc, 15, v4
    s_nop 0
    s_and_b64 s[46:47], vcc, 3
    s_waitcnt vmcnt(0)
    s_barrier
    ds_read_b128 v[64:67], v6 offset:0
    ds_read_b128 v[68:71], v6 offset:16384
    ds_read_b128 v[72:75], v6 offset:32768
    ds_read_b128 v[76:79], v6 offset:49152
    ds_read_b128 v[80:83], v6 offset:1024
    ds_read_b128 v[84:87], v6 offset:17408
    ds_read_b128 v[88:91], v6 offset:33792
    ds_read_b128 v[92:95], v6 offset:50176
    s_barrier
    s_barrier
    ds_read_b64_tr_b16 v[128:129], v8 offset:0
    ds_read_b64_tr_b16 v[130:131], v8 offset:1024
    ds_read_b64_tr_b16 v[132:133], v10 offset:0
    ds_read_b64_tr_b16 v[134:135], v10 offset:1024
    ds_read_b64_tr_b16 v[136:137], v8 offset:2048
    ds_read_b64_tr_b16 v[138:139], v8 offset:3072
    ds_read_b64_tr_b16 v[140:141], v10 offset:2048
    ds_read_b64_tr_b16 v[142:143], v10 offset:3072
    s_waitcnt lgkmcnt(4)
    v_mov_b32 v12, v128
    v_mov_b32 v4, v132
    v_and_b32 v128, v9, v128
    v_and_b32 v132, v9, v132
    v_mov_b32 v9, v4
    v_mfma_f32_16x16x32_bf16 v[32:35], v[64:67], v[128:131], 0
    ds_read_b128 v[112:115], v6 offset:2048
    v_mfma_f32_16x16x32_bf16 v[36:39], v[64:67], v[132:135], 0
    ds_read_b128 v[116:119], v6 offset:18432
    v_mfma_f32_16x16x32_bf16 v[40:43], v[68:71], v[128:131], 0
    ds_read_b128 v[120:123], v6 offset:34816
    v_mfma_f32_16x16x32_bf16 v[44:47], v[68:71], v[132:135], 0
    ds_read_b128 v[124:127], v6 offset:51200
    v_mfma_f32_16x16x32_bf16 v[48:51], v[128:131], v[72:75], 0
    s_waitcnt lgkmcnt(4)
    s_barrier
    ds_read_b64_tr_b16 v[144:145], v8 offset:4096
    v_mfma_f32_16x16x32_bf16 v[52:55], v[132:135], v[72:75], 0
    ds_read_b64_tr_b16 v[146:147], v8 offset:5120
    v_mfma_f32_16x16x32_bf16 v[56:59], v[128:131], v[76:79], 0
    ds_read_b64_tr_b16 v[148:149], v10 offset:4096
    v_mfma_f32_16x16x32_bf16 v[60:63], v[132:135], v[76:79], 0
    ds_read_b64_tr_b16 v[150:151], v10 offset:5120
    v_mfma_f32_16x16x32_bf16 v[32:35], v[80:83], v[136:139], v[32:35]
    ds_read_b128 v[64:67], v6 offset:3072
    v_mfma_f32_16x16x32_bf16 v[36:39], v[80:83], v[140:143], v[36:39]
    ds_read_b128 v[68:71], v6 offset:19456
    v_mfma_f32_16x16x32_bf16 v[40:43], v[84:87], v[136:139], v[40:43]
    ds_read_b128 v[72:75], v6 offset:35840
    v_mfma_f32_16x16x32_bf16 v[44:47], v[84:87], v[140:143], v[44:47]
    ds_read_b128 v[76:79], v6 offset:52224
    v_mfma_f32_16x16x32_bf16 v[48:51], v[136:139], v[88:91], v[48:51]
    ds_read_b64_tr_b16 v[152:153], v8 offset:6144
    v_mfma_f32_16x16x32_bf16 v[52:55], v[140:143], v[88:91], v[52:55]
    ds_read_b64_tr_b16 v[154:155], v8 offset:7168
    v_mfma_f32_16x16x32_bf16 v[56:59], v[136:139], v[92:95], v[56:59]
    ds_read_b64_tr_b16 v[156:157], v10 offset:6144
    v_mfma_f32_16x16x32_bf16 v[60:63], v[140:143], v[92:95], v[60:63]
    ds_read_b64_tr_b16 v[158:159], v10 offset:7168
    s_waitcnt lgkmcnt(8)
    s_nop 0
    v_mfma_f32_16x16x32_bf16 v[32:35], v[112:115], v[144:147], v[32:35]
    ds_read_b128 v[80:83], v6 offset:4096
    v_mfma_f32_16x16x32_bf16 v[36:39], v[112:115], v[148:151], v[36:39]
    ds_read_b128 v[84:87], v6 offset:20480
    v_mfma_f32_16x16x32_bf16 v[40:43], v[116:119], v[144:147], v[40:43]
    ds_read_b128 v[88:91], v6 offset:36864
    v_mfma_f32_16x16x32_bf16 v[44:47], v[116:119], v[148:151], v[44:47]
    ds_read_b128 v[92:95], v6 offset:53248
    v_mfma_f32_16x16x32_bf16 v[48:51], v[144:147], v[120:123], v[48:51]
    s_waitcnt lgkmcnt(4)
    s_barrier
    ds_read_b64_tr_b16 v[160:161], v16 offset:0
    v_mfma_f32_16x16x32_bf16 v[52:55], v[148:151], v[120:123], v[52:55]
    ds_read_b64_tr_b16 v[162:163], v16 offset:1024
    v_mfma_f32_16x16x32_bf16 v[56:59], v[144:147], v[124:127], v[56:59]
    ds_read_b64_tr_b16 v[164:165], v17 offset:0
    v_mfma_f32_16x16x32_bf16 v[60:63], v[148:151], v[124:127], v[60:63]
    ds_read_b64_tr_b16 v[166:167], v17 offset:1024
    v_mfma_f32_16x16x32_bf16 v[32:35], v[64:67], v[152:155], v[32:35]
    ds_read_b128 v[112:115], v6 offset:5120
    v_mfma_f32_16x16x32_bf16 v[36:39], v[64:67], v[156:159], v[36:39]
    ds_read_b128 v[116:119], v6 offset:21504
    v_mfma_f32_16x16x32_bf16 v[40:43], v[68:71], v[152:155], v[40:43]
    ds_read_b128 v[120:123], v6 offset:37888
    v_mfma_f32_16x16x32_bf16 v[44:47], v[68:71], v[156:159], v[44:47]
    ds_read_b128 v[124:127], v6 offset:54272
    v_mfma_f32_16x16x32_bf16 v[48:51], v[152:155], v[72:75], v[48:51]
    ds_read_b64_tr_b16 v[168:169], v16 offset:2048
    v_mfma_f32_16x16x32_bf16 v[52:55], v[156:159], v[72:75], v[52:55]
    ds_read_b64_tr_b16 v[170:171], v16 offset:3072
    v_mfma_f32_16x16x32_bf16 v[56:59], v[152:155], v[76:79], v[56:59]
    ds_read_b64_tr_b16 v[172:173], v17 offset:2048
    v_mfma_f32_16x16x32_bf16 v[60:63], v[156:159], v[76:79], v[60:63]
    ds_read_b64_tr_b16 v[174:175], v17 offset:3072
    s_waitcnt lgkmcnt(8)
    s_nop 0
    v_mfma_f32_16x16x32_bf16 v[32:35], v[80:83], v[160:163], v[32:35]
    ds_read_b128 v[64:67], v6 offset:6144
    v_mfma_f32_16x16x32_bf16 v[36:39], v[80:83], v[164:167], v[36:39]
    ds_read_b128 v[68:71], v6 offset:22528
    v_mfma_f32_16x16x32_bf16 v[40:43], v[84:87], v[160:163], v[40:43]
    ds_read_b128 v[72:75], v6 offset:38912
    v_mfma_f32_16x16x32_bf16 v[44:47], v[84:87], v[164:167], v[44:47]
    ds_read_b128 v[76:79], v6 offset:55296
    v_mfma_f32_16x16x32_bf16 v[48:51], v[160:163], v[88:91], v[48:51]
    s_waitcnt lgkmcnt(4)
    s_barrier
    ds_read_b64_tr_b16 v[176:177], v16 offset:4096
    v_mfma_f32_16x16x32_bf16 v[52:55], v[164:167], v[88:91], v[52:55]
    ds_read_b64_tr_b16 v[178:179], v16 offset:5120
    v_mfma_f32_16x16x32_bf16 v[56:59], v[160:163], v[92:95], v[56:59]
    ds_read_b64_tr_b16 v[180:181], v17 offset:4096
    v_mfma_f32_16x16x32_bf16 v[60:63], v[164:167], v[92:95], v[60:63]
    ds_read_b64_tr_b16 v[182:183], v17 offset:5120
    v_mfma_f32_16x16x32_bf16 v[32:35], v[112:115], v[168:171], v[32:35]
    ds_read_b128 v[80:83], v6 offset:7168
    v_mfma_f32_16x16x32_bf16 v[36:39], v[112:115], v[172:175], v[36:39]
    ds_read_b128 v[84:87], v6 offset:23552
    v_mfma_f32_16x16x32_bf16 v[40:43], v[116:119], v[168:171], v[40:43]
    ds_read_b128 v[88:91], v6 offset:39936
    v_mfma_f32_16x16x32_bf16 v[44:47], v[116:119], v[172:175], v[44:47]
    ds_read_b128 v[92:95], v6 offset:56320
    v_mfma_f32_16x16x32_bf16 v[48:51], v[168:171], v[120:123], v[48:51]
    ds_read_b64_tr_b16 v[184:185], v16 offset:6144
    v_mfma_f32_16x16x32_bf16 v[52:55], v[172:175], v[120:123], v[52:55]
    ds_read_b64_tr_b16 v[186:187], v16 offset:7168
    v_mfma_f32_16x16x32_bf16 v[56:59], v[168:171], v[124:127], v[56:59]
    ds_read_b64_tr_b16 v[188:189], v17 offset:6144
    v_mfma_f32_16x16x32_bf16 v[60:63], v[172:175], v[124:127], v[60:63]
    ds_read_b64_tr_b16 v[190:191], v17 offset:7168
    s_waitcnt lgkmcnt(8)
    s_nop 0
    v_mfma_f32_16x16x32_bf16 v[32:35], v[64:67], v[176:179], v[32:35]
    ds_read_b128 v[112:115], v6 offset:8192
    v_mfma_f32_16x16x32_bf16 v[36:39], v[64:67], v[180:183], v[36:39]
    ds_read_b128 v[116:119], v6 offset:24576
    v_mfma_f32_16x16x32_bf16 v[40:43], v[68:71], v[176:179], v[40:43]
    ds_read_b128 v[120:123], v6 offset:40960
    v_mfma_f32_16x16x32_bf16 v[44:47], v[68:71], v[180:183], v[44:47]
    ds_read_b128 v[124:127], v6 offset:57344
    v_mfma_f32_16x16x32_bf16 v[48:51], v[176:179], v[72:75], v[48:51]
    s_waitcnt lgkmcnt(4)
    s_barrier
    ds_read_b64_tr_b16 v[192:193], v8 offset:8192
    v_mfma_f32_16x16x32_bf16 v[52:55], v[180:183], v[72:75], v[52:55]
    ds_read_b64_tr_b16 v[194:195], v8 offset:9216
    v_mfma_f32_16x16x32_bf16 v[56:59], v[176:179], v[76:79], v[56:59]
    ds_read_b64_tr_b16 v[196:197], v10 offset:8192
    v_mfma_f32_16x16x32_bf16 v[60:63], v[180:183], v[76:79], v[60:63]
    ds_read_b64_tr_b16 v[198:199], v10 offset:9216
    v_mfma_f32_16x16x32_bf16 v[32:35], v[80:83], v[184:187], v[32:35]
    ds_read_b128 v[64:67], v6 offset:9216
    v_mfma_f32_16x16x32_bf16 v[36:39], v[80:83], v[188:191], v[36:39]
    ds_read_b128 v[68:71], v6 offset:25600
    v_mfma_f32_16x16x32_bf16 v[40:43], v[84:87], v[184:187], v[40:43]
    ds_read_b128 v[72:75], v6 offset:41984
    v_mfma_f32_16x16x32_bf16 v[44:47], v[84:87], v[188:191], v[44:47]
    ds_read_b128 v[76:79], v6 offset:58368
    v_mfma_f32_16x16x32_bf16 v[48:51], v[184:187], v[88:91], v[48:51]
    ds_read_b64_tr_b16 v[200:201], v8 offset:10240
    v_mfma_f32_16x16x32_bf16 v[52:55], v[188:191], v[88:91], v[52:55]
    ds_read_b64_tr_b16 v[202:203], v8 offset:11264
    v_mfma_f32_16x16x32_bf16 v[56:59], v[184:187], v[92:95], v[56:59]
    ds_read_b64_tr_b16 v[204:205], v10 offset:10240
    v_mfma_f32_16x16x32_bf16 v[60:63], v[188:191], v[92:95], v[60:63]
    ds_read_b64_tr_b16 v[206:207], v10 offset:11264
    s_waitcnt lgkmcnt(8)
    s_nop 0
    v_mfma_f32_16x16x32_bf16 v[32:35], v[112:115], v[192:195], v[32:35]
    ds_read_b128 v[80:83], v6 offset:10240
    v_mfma_f32_16x16x32_bf16 v[36:39], v[112:115], v[196:199], v[36:39]
    ds_read_b128 v[84:87], v6 offset:26624
    v_mfma_f32_16x16x32_bf16 v[40:43], v[116:119], v[192:195], v[40:43]
    ds_read_b128 v[88:91], v6 offset:43008
    v_mfma_f32_16x16x32_bf16 v[44:47], v[116:119], v[196:199], v[44:47]
    ds_read_b128 v[92:95], v6 offset:59392
    v_mfma_f32_16x16x32_bf16 v[48:51], v[192:195], v[120:123], v[48:51]
    s_waitcnt lgkmcnt(4)
    s_barrier
    ds_read_b64_tr_b16 v[208:209], v8 offset:12288
    v_mfma_f32_16x16x32_bf16 v[52:55], v[196:199], v[120:123], v[52:55]
    ds_read_b64_tr_b16 v[210:211], v8 offset:13312
    v_mfma_f32_16x16x32_bf16 v[56:59], v[192:195], v[124:127], v[56:59]
    ds_read_b64_tr_b16 v[212:213], v10 offset:12288
    v_mfma_f32_16x16x32_bf16 v[60:63], v[196:199], v[124:127], v[60:63]
    ds_read_b64_tr_b16 v[214:215], v10 offset:13312
    v_mfma_f32_16x16x32_bf16 v[32:35], v[64:67], v[200:203], v[32:35]
    ds_read_b128 v[112:115], v6 offset:11264
    v_mfma_f32_16x16x32_bf16 v[36:39], v[64:67], v[204:207], v[36:39]
    ds_read_b128 v[116:119], v6 offset:27648
    v_mfma_f32_16x16x32_bf16 v[40:43], v[68:71], v[200:203], v[40:43]
    ds_read_b128 v[120:123], v6 offset:44032
    v_mfma_f32_16x16x32_bf16 v[44:47], v[68:71], v[204:207], v[44:47]
    ds_read_b128 v[124:127], v6 offset:60416
    v_mfma_f32_16x16x32_bf16 v[48:51], v[200:203], v[72:75], v[48:51]
    ds_read_b64_tr_b16 v[216:217], v8 offset:14336
    v_mfma_f32_16x16x32_bf16 v[52:55], v[204:207], v[72:75], v[52:55]
    ds_read_b64_tr_b16 v[218:219], v8 offset:15360
    v_mfma_f32_16x16x32_bf16 v[56:59], v[200:203], v[76:79], v[56:59]
    ds_read_b64_tr_b16 v[220:221], v10 offset:14336
    v_mfma_f32_16x16x32_bf16 v[60:63], v[204:207], v[76:79], v[60:63]
    ds_read_b64_tr_b16 v[222:223], v10 offset:15360
    s_waitcnt lgkmcnt(8)
    s_nop 0
    v_mfma_f32_16x16x32_bf16 v[32:35], v[80:83], v[208:211], v[32:35]
    ds_read_b128 v[64:67], v6 offset:12288
    v_mfma_f32_16x16x32_bf16 v[36:39], v[80:83], v[212:215], v[36:39]
    ds_read_b128 v[68:71], v6 offset:28672
    v_mfma_f32_16x16x32_bf16 v[40:43], v[84:87], v[208:211], v[40:43]
    ds_read_b128 v[72:75], v6 offset:45056
    v_mfma_f32_16x16x32_bf16 v[44:47], v[84:87], v[212:215], v[44:47]
    ds_read_b128 v[76:79], v6 offset:61440
    v_mfma_f32_16x16x32_bf16 v[48:51], v[208:211], v[88:91], v[48:51]
    s_waitcnt lgkmcnt(4)
    s_barrier
    ds_read_b64_tr_b16 v[224:225], v8 offset:0
    v_mfma_f32_16x16x32_bf16 v[52:55], v[212:215], v[88:91], v[52:55]
    ds_read_b64_tr_b16 v[226:227], v8 offset:1024
    v_mfma_f32_16x16x32_bf16 v[56:59], v[208:211], v[92:95], v[56:59]
    ds_read_b64_tr_b16 v[228:229], v10 offset:0
    v_mfma_f32_16x16x32_bf16 v[60:63], v[212:215], v[92:95], v[60:63]
    ds_read_b64_tr_b16 v[230:231], v10 offset:1024
    v_mfma_f32_16x16x32_bf16 v[32:35], v[112:115], v[216:219], v[32:35]
    ds_read_b128 v[80:83], v6 offset:13312
    v_mfma_f32_16x16x32_bf16 v[36:39], v[112:115], v[220:223], v[36:39]
    ds_read_b128 v[84:87], v6 offset:29696
    v_mfma_f32_16x16x32_bf16 v[40:43], v[116:119], v[216:219], v[40:43]
    ds_read_b128 v[88:91], v6 offset:46080
    v_mfma_f32_16x16x32_bf16 v[44:47], v[116:119], v[220:223], v[44:47]
    ds_read_b128 v[92:95], v6 offset:62464
    v_mfma_f32_16x16x32_bf16 v[48:51], v[216:219], v[120:123], v[48:51]
    ds_read_b64_tr_b16 v[232:233], v8 offset:2048
    v_mfma_f32_16x16x32_bf16 v[52:55], v[220:223], v[120:123], v[52:55]
    ds_read_b64_tr_b16 v[234:235], v8 offset:3072
    v_mfma_f32_16x16x32_bf16 v[56:59], v[216:219], v[124:127], v[56:59]
    ds_read_b64_tr_b16 v[236:237], v10 offset:2048
    v_mfma_f32_16x16x32_bf16 v[60:63], v[220:223], v[124:127], v[60:63]
    ds_read_b64_tr_b16 v[238:239], v10 offset:3072
    s_waitcnt lgkmcnt(8)
    s_nop 0
    v_mfma_f32_16x16x32_bf16 v[32:35], v[64:67], v[224:227], v[32:35]
    ds_read_b128 v[112:115], v6 offset:14336
    v_mfma_f32_16x16x32_bf16 v[36:39], v[64:67], v[228:231], v[36:39]
    ds_read_b128 v[116:119], v6 offset:30720
    v_mfma_f32_16x16x32_bf16 v[40:43], v[68:71], v[224:227], v[40:43]
    ds_read_b128 v[120:123], v6 offset:47104
    v_mfma_f32_16x16x32_bf16 v[44:47], v[68:71], v[228:231], v[44:47]
    ds_read_b128 v[124:127], v6 offset:63488
    v_mfma_f32_16x16x32_bf16 v[48:51], v[224:227], v[72:75], v[48:51]
    s_waitcnt lgkmcnt(4)
    s_barrier
    ds_read_b64_tr_b16 v[240:241], v8 offset:4096
    v_mfma_f32_16x16x32_bf16 v[52:55], v[228:231], v[72:75], v[52:55]
    ds_read_b64_tr_b16 v[242:243], v8 offset:5120
    v_mfma_f32_16x16x32_bf16 v[56:59], v[224:227], v[76:79], v[56:59]
    ds_read_b64_tr_b16 v[244:245], v10 offset:4096
    v_mfma_f32_16x16x32_bf16 v[60:63], v[228:231], v[76:79], v[60:63]
    ds_read_b64_tr_b16 v[246:247], v10 offset:5120
    v_mfma_f32_16x16x32_bf16 v[32:35], v[80:83], v[232:235], v[32:35]
    ds_read_b128 v[64:67], v6 offset:15360
    v_mfma_f32_16x16x32_bf16 v[36:39], v[80:83], v[236:239], v[36:39]
    ds_read_b128 v[68:71], v6 offset:31744
    v_mfma_f32_16x16x32_bf16 v[40:43], v[84:87], v[232:235], v[40:43]
    ds_read_b128 v[72:75], v6 offset:48128
    v_mfma_f32_16x16x32_bf16 v[44:47], v[84:87], v[236:239], v[44:47]
    ds_read_b128 v[76:79], v6 offset:64512
    v_mfma_f32_16x16x32_bf16 v[48:51], v[232:235], v[88:91], v[48:51]
    ds_read_b64_tr_b16 v[248:249], v8 offset:6144
    v_mfma_f32_16x16x32_bf16 v[52:55], v[236:239], v[88:91], v[52:55]
    ds_read_b64_tr_b16 v[250:251], v8 offset:7168
    v_mfma_f32_16x16x32_bf16 v[56:59], v[232:235], v[92:95], v[56:59]
    ds_read_b64_tr_b16 v[252:253], v10 offset:6144
    v_mfma_f32_16x16x32_bf16 v[60:63], v[236:239], v[92:95], v[60:63]
    ds_read_b64_tr_b16 v[254:255], v10 offset:7168
    s_waitcnt lgkmcnt(8)
    s_nop 0
    v_mfma_f32_16x16x32_bf16 v[32:35], v[112:115], v[240:243], v[32:35]
    v_mfma_f32_16x16x32_bf16 v[36:39], v[112:115], v[244:247], v[36:39]
    v_mfma_f32_16x16x32_bf16 v[40:43], v[116:119], v[240:243], v[40:43]
    v_mfma_f32_16x16x32_bf16 v[44:47], v[116:119], v[244:247], v[44:47]
    v_mfma_f32_16x16x32_bf16 v[48:51], v[240:243], v[120:123], v[48:51]
    v_mfma_f32_16x16x32_bf16 v[52:55], v[244:247], v[120:123], v[52:55]
    v_mfma_f32_16x16x32_bf16 v[56:59], v[240:243], v[124:127], v[56:59]
    v_mfma_f32_16x16x32_bf16 v[60:63], v[244:247], v[124:127], v[60:63]
    s_waitcnt lgkmcnt(0)
    s_nop 0
    v_mfma_f32_16x16x32_bf16 v[32:35], v[64:67], v[248:251], v[32:35]
    v_mfma_f32_16x16x32_bf16 v[36:39], v[64:67], v[252:255], v[36:39]
    v_mfma_f32_16x16x32_bf16 v[40:43], v[68:71], v[248:251], v[40:43]
    v_mfma_f32_16x16x32_bf16 v[44:47], v[68:71], v[252:255], v[44:47]
    v_mfma_f32_16x16x32_bf16 v[48:51], v[248:251], v[72:75], v[48:51]
    v_mfma_f32_16x16x32_bf16 v[52:55], v[252:255], v[72:75], v[52:55]
    v_mfma_f32_16x16x32_bf16 v[56:59], v[248:251], v[76:79], v[56:59]
    v_mfma_f32_16x16x32_bf16 v[60:63], v[252:255], v[76:79], v[60:63]
    s_barrier
    s_nop 0
    ds_read_b32 v72, v15 offset:14336
    ds_read_b32 v74, v15 offset:14400
    ds_read_b128 v[64:67], v11 offset:14336
    ds_read_b128 v[68:71], v11 offset:14400
    ds_read_b128 v[112:115], v5 offset:0
    ds_read_b128 v[116:119], v5 offset:16384
    ds_read_b128 v[120:123], v5 offset:1024
    ds_read_b128 v[124:127], v5 offset:17408
    s_waitcnt lgkmcnt(6)
    v_mov_b32 v73, v72
    v_mov_b32_e64 v75, v74
    v_pk_mul_f32 v[32:33], v[32:33], v[72:73]
    v_pk_mul_f32 v[34:35], v[34:35], v[72:73]
    v_pk_mul_f32 v[36:37], v[36:37], v[74:75]
    v_pk_mul_f32 v[38:39], v[38:39], v[74:75]
    v_cvt_pk_bf16_f32 v32, v32, v33
    v_cvt_pk_bf16_f32 v33, v34, v35
    v_cvt_pk_bf16_f32 v34, v36, v37
    v_cvt_pk_bf16_f32 v35, v38, v39
    s_nop 0
    v_permlane16_swap_b32 v32, v34
    v_permlane16_swap_b32 v33, v35
    s_nop 0
    buffer_store_dwordx4 v[32:35], v6, s[8:11], s32 offen offset:0 sc1
    v_pk_mul_f32 v[40:41], v[40:41], v[72:73]
    v_pk_mul_f32 v[42:43], v[42:43], v[72:73]
    v_pk_mul_f32 v[44:45], v[44:45], v[74:75]
    v_pk_mul_f32 v[46:47], v[46:47], v[74:75]
    v_cvt_pk_bf16_f32 v36, v40, v41
    v_cvt_pk_bf16_f32 v37, v42, v43
    v_cvt_pk_bf16_f32 v38, v44, v45
    v_cvt_pk_bf16_f32 v39, v46, v47
    s_nop 0
    v_permlane16_swap_b32 v36, v38
    v_permlane16_swap_b32 v37, v39
    buffer_store_dwordx4 v[36:39], v6, s[8:11], s32 offen offset:1024 sc1
    s_waitcnt lgkmcnt(4)
    v_pk_mul_f32 v[48:49], v[48:49], v[64:65]
    v_pk_mul_f32 v[50:51], v[50:51], v[66:67]
    v_pk_mul_f32 v[56:57], v[56:57], v[64:65]
    v_pk_mul_f32 v[58:59], v[58:59], v[66:67]
    v_cvt_pk_bf16_f32 v40, v48, v49
    v_cvt_pk_bf16_f32 v41, v50, v51
    v_cvt_pk_bf16_f32 v42, v56, v57
    v_cvt_pk_bf16_f32 v43, v58, v59
    s_nop 0
    v_permlane16_swap_b32 v40, v42
    v_permlane16_swap_b32 v41, v43
    s_nop 0
    v_permlane32_swap_b32 v40, v42
    v_permlane32_swap_b32 v41, v43
    buffer_store_dwordx4 v[40:43], v6, s[8:11], s32 offen offset:2048 sc1
    v_pk_mul_f32 v[52:53], v[52:53], v[68:69]
    v_pk_mul_f32 v[54:55], v[54:55], v[70:71]
    v_pk_mul_f32 v[60:61], v[60:61], v[68:69]
    v_pk_mul_f32 v[62:63], v[62:63], v[70:71]
    v_cvt_pk_bf16_f32 v44, v52, v53
    v_cvt_pk_bf16_f32 v45, v54, v55
    v_cvt_pk_bf16_f32 v46, v60, v61
    v_cvt_pk_bf16_f32 v47, v62, v63
    s_nop 0
    v_permlane16_swap_b32 v44, v46
    v_permlane16_swap_b32 v45, v47
    s_nop 0
    v_permlane32_swap_b32 v44, v46
    v_permlane32_swap_b32 v45, v47
    buffer_store_dwordx4 v[44:47], v6, s[8:11], s32 offen offset:3072 sc1
    s_waitcnt lgkmcnt(2)
    s_nop 0
    v_mfma_f32_16x16x32_bf16 v[16:19], v[112:115], v[128:131], 0
    ds_read_b128 v[88:91], v5 offset:2048
    ds_read_b128 v[92:95], v5 offset:18432
    v_mfma_f32_16x16x32_bf16 v[20:23], v[112:115], v[132:135], 0
    ds_write_b128 v7, v[32:35] offset:0
    v_mfma_f32_16x16x32_bf16 v[24:27], v[116:119], v[128:131], 0
    v_mfma_f32_16x16x32_bf16 v[28:31], v[116:119], v[132:135], 0
    ds_write_b128 v7, v[36:39] offset:1024
    s_waitcnt lgkmcnt(4)
    s_nop 0
    v_mfma_f32_16x16x32_bf16 v[16:19], v[120:123], v[136:139], v[16:19]
    ds_read_b128 v[112:115], v5 offset:3072
    ds_read_b128 v[116:119], v5 offset:19456
    v_mfma_f32_16x16x32_bf16 v[20:23], v[120:123], v[140:143], v[20:23]
    ds_write_b128 v7, v[40:43] offset:2048
    v_mfma_f32_16x16x32_bf16 v[24:27], v[124:127], v[136:139], v[24:27]
    v_mfma_f32_16x16x32_bf16 v[28:31], v[124:127], v[140:143], v[28:31]
    ds_write_b128 v7, v[44:47] offset:3072
    s_waitcnt lgkmcnt(6)
    s_nop 0
    v_mfma_f32_16x16x32_bf16 v[16:19], v[88:91], v[144:147], v[16:19]
    ds_read_b128 v[120:123], v5 offset:4096
    ds_read_b128 v[124:127], v5 offset:20480
    v_mfma_f32_16x16x32_bf16 v[20:23], v[88:91], v[148:151], v[20:23]
    v_mfma_f32_16x16x32_bf16 v[24:27], v[92:95], v[144:147], v[24:27]
    v_mul_f32 v10, 0x3eb8aa3b, v72
    v_mfma_f32_16x16x32_bf16 v[28:31], v[92:95], v[148:151], v[28:31]
    v_mul_f32 v56, 0x3eb8aa3b, v74
    v_mov_b32 v11, v10
    s_waitcnt lgkmcnt(4)
    v_mfma_f32_16x16x32_bf16 v[16:19], v[112:115], v[152:155], v[16:19]
    ds_read_b128 v[88:91], v5 offset:5120
    ds_read_b128 v[92:95], v5 offset:21504
    v_mfma_f32_16x16x32_bf16 v[20:23], v[112:115], v[156:159], v[20:23]
    v_mov_b32_e64 v57, v56
    v_mul_u32_u24 v49, 7936, v1
    v_mfma_f32_16x16x32_bf16 v[24:27], v[116:119], v[152:155], v[24:27]
    v_mov_b32_e64 v48, s36
    v_mfma_f32_16x16x32_bf16 v[28:31], v[116:119], v[156:159], v[28:31]
    v_mov_b32_e64 v50, v9
    s_lshl_b32 s45, s26, 10
    s_waitcnt lgkmcnt(2)
    v_mfma_f32_16x16x32_bf16 v[16:19], v[120:123], v[160:163], v[16:19]
    ds_read_b128 v[112:115], v5 offset:6144
    ds_read_b128 v[116:119], v5 offset:22528
    v_mfma_f32_16x16x32_bf16 v[20:23], v[120:123], v[164:167], v[20:23]
    v_add_u32 v8, s45, v6
    v_and_b32 v9, 47, v1
    v_mfma_f32_16x16x32_bf16 v[24:27], v[124:127], v[160:163], v[24:27]
    v_lshlrev_b32_e64 v9, 4, v9
    v_mfma_f32_16x16x32_bf16 v[28:31], v[124:127], v[164:167], v[28:31]
    s_lshl_b32 s45, s26, 8
    s_add_u32 s45, s45, 2048
    s_waitcnt lgkmcnt(2)
    v_mfma_f32_16x16x32_bf16 v[16:19], v[88:91], v[168:171], v[16:19]
    ds_read_b128 v[120:123], v5 offset:7168
    ds_read_b128 v[124:127], v5 offset:23552
    v_mfma_f32_16x16x32_bf16 v[20:23], v[88:91], v[172:175], v[20:23]
    v_add_u32_e64 v9, s45, v9
    v_mov_b32 v72, 0x3f803f80
    v_mfma_f32_16x16x32_bf16 v[24:27], v[92:95], v[168:171], v[24:27]
    v_mov_b32 v73, 0x3f803f80
    v_mfma_f32_16x16x32_bf16 v[28:31], v[92:95], v[172:175], v[28:31]
    v_mov_b32 v74, 0x3f803f80
    v_mov_b32 v75, 0x3f803f80
    s_waitcnt lgkmcnt(2)
    s_nop 0
    v_mfma_f32_16x16x32_bf16 v[16:19], v[112:115], v[176:179], v[16:19]
    ds_read_b128 v[88:91], v5 offset:8192
    ds_read_b128 v[92:95], v5 offset:24576
    v_mfma_f32_16x16x32_bf16 v[20:23], v[112:115], v[180:183], v[20:23]
    v_mov_b32 v76, 0x3f803f80
    v_mov_b32 v77, 0x3f803f80
    v_mfma_f32_16x16x32_bf16 v[24:27], v[116:119], v[176:179], v[24:27]
    v_mov_b32 v78, 0x3f803f80
    v_mfma_f32_16x16x32_bf16 v[28:31], v[116:119], v[180:183], v[28:31]
    v_mov_b32 v79, 0x3f803f80
    v_mov_b32 v80, 0x3f803f80
    s_waitcnt lgkmcnt(2)
    s_nop 0
    v_mfma_f32_16x16x32_bf16 v[16:19], v[120:123], v[184:187], v[16:19]
    ds_read_b128 v[112:115], v5 offset:9216
    ds_read_b128 v[116:119], v5 offset:25600
    v_mfma_f32_16x16x32_bf16 v[20:23], v[120:123], v[188:191], v[20:23]
    v_mov_b32 v81, 0x3f803f80
    v_mov_b32 v82, 0x3f803f80
    v_mfma_f32_16x16x32_bf16 v[24:27], v[124:127], v[184:187], v[24:27]
    v_mov_b32 v83, 0x3f803f80
    v_mfma_f32_16x16x32_bf16 v[28:31], v[124:127], v[188:191], v[28:31]
    v_mov_b32 v84, 0x3f803f80
    v_mov_b32 v85, 0x3f803f80
    s_waitcnt lgkmcnt(2)
    s_nop 0
    v_mfma_f32_16x16x32_bf16 v[16:19], v[88:91], v[192:195], v[16:19]
    ds_read_b128 v[120:123], v5 offset:10240
    ds_read_b128 v[124:127], v5 offset:26624
    v_mfma_f32_16x16x32_bf16 v[20:23], v[88:91], v[196:199], v[20:23]
    v_mov_b32 v86, 0x3f803f80
    v_mov_b32 v87, 0x3f803f80
    v_mfma_f32_16x16x32_bf16 v[24:27], v[92:95], v[192:195], v[24:27]
    s_mov_b32 s38, 0xffff
    v_mfma_f32_16x16x32_bf16 v[28:31], v[92:95], v[196:199], v[28:31]
    s_mov_b32 s39, 0xffff
    s_lshl_b32 s60, s57, 3
    s_waitcnt lgkmcnt(2)
    v_mfma_f32_16x16x32_bf16 v[16:19], v[112:115], v[200:203], v[16:19]
    ds_read_b128 v[88:91], v5 offset:11264
    ds_read_b128 v[92:95], v5 offset:27648
    v_mfma_f32_16x16x32_bf16 v[20:23], v[112:115], v[204:207], v[20:23]
    s_add_u32 s60, s60, s24
    s_lshl_b32 s45, s60, 10
    v_mfma_f32_16x16x32_bf16 v[24:27], v[116:119], v[200:203], v[24:27]
    s_lshl_b32 s60, s60, 14
    v_mfma_f32_16x16x32_bf16 v[28:31], v[116:119], v[204:207], v[28:31]
    s_lshl_b32 s48, s55, 19
    s_add_u32 s60, s60, s48
    s_waitcnt lgkmcnt(2)
    v_mfma_f32_16x16x32_bf16 v[16:19], v[120:123], v[208:211], v[16:19]
    ds_read_b128 v[112:115], v5 offset:12288
    ds_read_b128 v[116:119], v5 offset:28672
    v_mfma_f32_16x16x32_bf16 v[20:23], v[120:123], v[212:215], v[20:23]
    s_add_u32 s60, s60, 11534336
    s_lshl_b32 s48, s56, 15
    v_mfma_f32_16x16x32_bf16 v[24:27], v[124:127], v[208:211], v[24:27]
    s_add_u32 s45, s45, s48
    v_mfma_f32_16x16x32_bf16 v[28:31], v[124:127], v[212:215], v[28:31]
    s_add_u32 s43, s45, s51
    s_waitcnt lgkmcnt(2)
    v_mfma_f32_16x16x32_bf16 v[16:19], v[88:91], v[216:219], v[16:19]
    ds_read_b128 v[120:123], v5 offset:13312
    ds_read_b128 v[124:127], v5 offset:29696
    v_mfma_f32_16x16x32_bf16 v[20:23], v[88:91], v[220:223], v[20:23]
    v_mfma_f32_16x16x32_bf16 v[24:27], v[92:95], v[216:219], v[24:27]
    v_mfma_f32_16x16x32_bf16 v[28:31], v[92:95], v[220:223], v[28:31]
    s_waitcnt lgkmcnt(2)
    s_nop 0
    v_mfma_f32_16x16x32_bf16 v[16:19], v[112:115], v[224:227], v[16:19]
    ds_read_b128 v[88:91], v5 offset:14336
    ds_read_b128 v[92:95], v5 offset:30720
    v_mfma_f32_16x16x32_bf16 v[20:23], v[112:115], v[228:231], v[20:23]
    v_mfma_f32_16x16x32_bf16 v[24:27], v[116:119], v[224:227], v[24:27]
    v_mfma_f32_16x16x32_bf16 v[28:31], v[116:119], v[228:231], v[28:31]
    s_waitcnt lgkmcnt(2)
    s_nop 0
    v_mfma_f32_16x16x32_bf16 v[16:19], v[120:123], v[232:235], v[16:19]
    ds_read_b128 v[112:115], v5 offset:15360
    ds_read_b128 v[116:119], v5 offset:31744
    v_mfma_f32_16x16x32_bf16 v[20:23], v[120:123], v[236:239], v[20:23]
    v_mfma_f32_16x16x32_bf16 v[24:27], v[124:127], v[232:235], v[24:27]
    v_mfma_f32_16x16x32_bf16 v[28:31], v[124:127], v[236:239], v[28:31]
    s_waitcnt lgkmcnt(2)
    v_mfma_f32_16x16x32_bf16 v[16:19], v[88:91], v[240:243], v[16:19]
    v_mfma_f32_16x16x32_bf16 v[20:23], v[88:91], v[244:247], v[20:23]
    v_mfma_f32_16x16x32_bf16 v[24:27], v[92:95], v[240:243], v[24:27]
    v_mfma_f32_16x16x32_bf16 v[28:31], v[92:95], v[244:247], v[28:31]
    s_waitcnt lgkmcnt(0)
    v_mfma_f32_16x16x32_bf16 v[16:19], v[112:115], v[248:251], v[16:19]
    v_mfma_f32_16x16x32_bf16 v[20:23], v[112:115], v[252:255], v[20:23]
    v_mfma_f32_16x16x32_bf16 v[24:27], v[116:119], v[248:251], v[24:27]
    v_mfma_f32_16x16x32_bf16 v[28:31], v[116:119], v[252:255], v[28:31]
    v_mov_b32 v128, v12
    v_mov_b32_e64 v132, v50
    s_nop 4
    v_pk_mul_f32 v[24:25], v[24:25], v[10:11]
    v_pk_mul_f32 v[26:27], v[26:27], v[10:11]
    v_pk_mul_f32 v[28:29], v[28:29], v[56:57]
    v_pk_mul_f32 v[30:31], v[30:31], v[56:57]
    v_cvt_pk_bf16_f32 v52, v24, v25
    v_cvt_pk_bf16_f32 v53, v26, v27
    v_cvt_pk_bf16_f32 v54, v28, v29
    v_cvt_pk_bf16_f32 v55, v30, v31
    s_nop 0
    v_permlane16_swap_b32 v52, v54
    v_permlane16_swap_b32 v53, v55
    s_nop 0
    ds_write_b128 v7, v[52:55] offset:4096
    v_pk_mul_f32 v[16:17], v[16:17], v[10:11]
    v_pk_mul_f32 v[18:19], v[18:19], v[10:11]
    v_pk_mul_f32 v[20:21], v[20:21], v[56:57]
    v_pk_mul_f32 v[22:23], v[22:23], v[56:57]
    v_cvt_pk_bf16_f32 v16, v16, v17
    v_cvt_pk_bf16_f32 v17, v18, v19
    v_cvt_pk_bf16_f32 v18, v20, v21
    v_cvt_pk_bf16_f32 v19, v22, v23
    s_nop 0
    v_permlane16_swap_b32 v16, v18
    v_permlane16_swap_b32 v17, v19
    v_add_u32 v20, s40, v8
    v_add_u32 v21, s40, v9
    v_add_u32 v22, s42, v8
    v_add_u32_e64 v23, s42, v9
    s_waitcnt vmcnt(0)
    s_mov_b64 exec, s[46:47]
    buffer_store_dword v48, v49, s[8:11], s44 offen sc1
    s_mov_b64 exec, -1
    s_waitcnt lgkmcnt(0)
    s_barrier
    s_branch attn_19
helper_18:
    s_cmp_lg_u32 s55, 0
    s_cbranch_scc1 nob_27
    v_lshlrev_b32_e64 v4, 2, v3
    v_sub_u32 v4, v2, v4
    v_cvt_f32_i32 v4, v4
    v_mul_f32 v4, 0x71800000, v4
    v_subrev_f32 v96, 0x00000000, v4
    v_min_f32 v96, 0, v96
    v_subrev_f32 v97, 0x71800000, v4
    v_min_f32_e64 v97, 0, v97
    v_subrev_f32 v98, 0x72000000, v4
    v_min_f32_e64 v98, 0, v98
    v_subrev_f32 v99, 0x72400000, v4
    v_min_f32_e64 v99, 0, v99
    v_subrev_f32 v100, 0x73000000, v4
    v_min_f32_e64 v100, 0, v100
    v_subrev_f32 v101, 0x73100000, v4
    v_min_f32_e64 v101, 0, v101
    v_subrev_f32 v102, 0x73200000, v4
    v_min_f32_e64 v102, 0, v102
    v_subrev_f32 v103, 0x73300000, v4
    v_min_f32_e64 v103, 0, v103
    v_subrev_f32 v104, 0x73800000, v4
    v_min_f32_e64 v104, 0, v104
    v_subrev_f32 v105, 0x73880000, v4
    v_min_f32_e64 v105, 0, v105
    v_subrev_f32 v106, 0x73900000, v4
    v_min_f32_e64 v106, 0, v106
    v_subrev_f32 v107, 0x73980000, v4
    v_min_f32_e64 v107, 0, v107
    v_subrev_f32 v108, 0x73c00000, v4
    v_min_f32_e64 v108, 0, v108
    v_subrev_f32 v109, 0x73c80000, v4
    v_min_f32_e64 v109, 0, v109
    v_subrev_f32 v110, 0x73d00000, v4
    v_min_f32_e64 v110, 0, v110
    v_subrev_f32 v111, 0x73d80000, v4
    v_min_f32 v111, 0, v111
    v_mov_b32 v8, -1
    v_mov_b32 v9, -1
    v_mov_b32 v10, -1
    v_mov_b32_e64 v11, -1
    v_and_b32 v5, 255, v0
    v_lshlrev_b32 v5, 4, v5
    s_lshl_b32 s35, s2, 13
    s_add_u32 s32, s35, 4194304
    buffer_store_dwordx4 v[8:11], v5, s[8:11], s32 offen sc1
    s_add_u32 s32, s35, 4198400
    buffer_store_dwordx4 v[8:11], v5, s[8:11], s32 offen sc1
    s_add_u32 s32, s35, 25165824
    buffer_store_dwordx4 v[8:11], v5, s[8:11], s32 offen sc1
    s_add_u32 s32, s35, 25169920
    buffer_store_dwordx4 v[8:11], v5, s[8:11], s32 offen sc1
    v_min_u32 v4, 11, v1
    v_lshrrev_b32 v7, 2, v4
    v_and_b32 v4, 3, v4
    v_lshlrev_b32 v7, 12, v7
    v_lshl_or_b32 v7, v4, 6, v7
    s_lshl_b32 s45, s29, 8
    s_add_u32 s45, s45, 33882112
    s_lshl_b32 s33, s25, 13
    s_lshl_b32 s34, s29, 15
    s_add_u32 s34, s34, s33
    s_waitcnt vmcnt(0)
    s_barrier
    s_cmp_lg_u32 s24, 4
    s_cbranch_scc1 nfb_29
    s_mov_b64 exec, 1
    buffer_store_dword v52, v53, s[8:11], s37 offen sc1
    s_mov_b64 exec, -1
nfb_29:
    s_barrier
fpoll_30:
    buffer_load_dword v5, v7, s[8:11], s45 offen sc1
    s_waitcnt vmcnt(0)
    v_cmp_ne_u32 vcc, s36, v5
    s_nop 0
    s_cbranch_vccz px_31
    s_sub_u32 s58, s58, 1
    s_cbranch_scc0 fpoll_30
    s_mov_b32 s58, 0
px_31:
    s_add_u32 s32, s34, 9961472
    s_add_u32 m0, s33, 0
    s_nop 0
    buffer_load_dwordx4 v6, s[8:11], s32 offen offset:0 sc1 lds
    buffer_load_dwordx4 v6, s[8:11], s32 offen offset:1024 sc1 lds
    buffer_load_dwordx4 v6, s[8:11], s32 offen offset:2048 sc1 lds
    buffer_load_dwordx4 v6, s[8:11], s32 offen offset:3072 sc1 lds
    s_add_u32 s32, s34, 9965568
    s_add_u32 m0, s33, 4096
    s_nop 0
    s_nop 0
    buffer_load_dwordx4 v6, s[8:11], s32 offen offset:0 sc1 lds
    buffer_load_dwordx4 v6, s[8:11], s32 offen offset:1024 sc1 lds
    buffer_load_dwordx4 v6, s[8:11], s32 offen offset:2048 sc1 lds
    buffer_load_dwordx4 v6, s[8:11], s32 offen offset:3072 sc1 lds
    s_add_u32 s32, s34, 10485760
    s_add_u32 m0, s33, 32768
    s_nop 0
    s_nop 0
    buffer_load_dwordx4 v6, s[8:11], s32 offen offset:0 sc1 lds
    buffer_load_dwordx4 v6, s[8:11], s32 offen offset:1024 sc1 lds
    buffer_load_dwordx4 v6, s[8:11], s32 offen offset:2048 sc1 lds
    buffer_load_dwordx4 v6, s[8:11], s32 offen offset:3072 sc1 lds
    s_add_u32 s32, s34, 10489856
    s_add_u32 m0, s33, 36864
    s_nop 0
    buffer_load_dwordx4 v6, s[8:11], s32 offen offset:0 sc1 lds
    buffer_load_dwordx4 v6, s[8:11], s32 offen offset:1024 sc1 lds
    buffer_load_dwordx4 v6, s[8:11], s32 offen offset:2048 sc1 lds
    buffer_load_dwordx4 v6, s[8:11], s32 offen offset:3072 sc1 lds
    s_branch nob2_28
nob_27:
    s_barrier
    s_lshl_b32 s60, s57, 3
    s_add_u32 s60, s60, s24
    s_lshl_b32 s60, s60, 14
    s_lshl_b32 s33, s55, 19
    s_add_u32 s60, s60, s33
    s_add_u32 s60, s60, 11534336
    buffer_load_dwordx4 v[192:195], v6, s[8:11], s60 offen offset:0 sc1
    buffer_load_dwordx4 v[196:199], v6, s[8:11], s60 offen offset:1024 sc1
    buffer_load_dwordx4 v[200:203], v6, s[8:11], s60 offen offset:2048 sc1
    buffer_load_dwordx4 v[204:207], v6, s[8:11], s60 offen offset:3072 sc1
    s_add_u32 s60, s60, 4096
    buffer_load_dwordx4 v[208:211], v6, s[8:11], s60 offen offset:0 sc1
    buffer_load_dwordx4 v[212:215], v6, s[8:11], s60 offen offset:1024 sc1
    buffer_load_dwordx4 v[216:219], v6, s[8:11], s60 offen offset:2048 sc1
    buffer_load_dwordx4 v[220:223], v6, s[8:11], s60 offen offset:3072 sc1
    s_add_u32 s60, s60, 4096
    buffer_load_dwordx4 v[224:227], v6, s[8:11], s60 offen offset:0 sc1
    buffer_load_dwordx4 v[228:231], v6, s[8:11], s60 offen offset:1024 sc1
    buffer_load_dwordx4 v[232:235], v6, s[8:11], s60 offen offset:2048 sc1
    buffer_load_dwordx4 v[236:239], v6, s[8:11], s60 offen offset:3072 sc1
    s_add_u32 s60, s60, 4096
    buffer_load_dwordx4 v[240:243], v6, s[8:11], s60 offen offset:0 sc1
    buffer_load_dwordx4 v[244:247], v6, s[8:11], s60 offen offset:1024 sc1
    buffer_load_dwordx4 v[248:251], v6, s[8:11], s60 offen offset:2048 sc1
    buffer_load_dwordx4 v[252:255], v6, s[8:11], s60 offen offset:3072 sc1
    s_barrier
nob2_28:
    s_waitcnt vmcnt(0)
    s_lshl_b32 s31, s25, 14
    s_add_u32 s31, s31, 98304
    s_lshl_b32 s59, s27, 15
    s_add_u32 s59, s59, s51
    v_bfe_u32 v8, v1, 2, 2
    v_lshl_add_u32 v8, v3, 2, v8
    v_lshlrev_b32 v8, 6, v8
    v_bfe_u32 v4, v1, 4, 1
    v_xor_b32_e64 v4, v4, v3
    v_lshl_or_b32 v8, v4, 5, v8
    v_and_b32_e64 v4, 3, v1
    v_lshl_or_b32 v8, v4, 3, v8
    v_add_u32 v8, s31, v8
    v_lshlrev_b32_e64 v9, 16, v3
    v_sub_u32 v9, v9, v3
    v_or_b32 v9, 0xffff0000, v9
    v_bfe_u32 v12, v1, 4, 1
    v_lshlrev_b32 v12, 5, v12
    v_xor_b32 v12, v12, v6
    s_mov_b32 s38, 0xaaaaaaaa
    s_mov_b32 s39, 0xaaaaaaaa
    s_mov_b32 s4, 0xcccccccc
    s_mov_b32 s5, 0xcccccccc
    s_lshl_b32 s60, s57, 3
    s_add_u32 s60, s60, s24
    s_lshl_b32 s60, s60, 14
    s_lshl_b32 s33, s55, 19
    s_add_u32 s60, s60, s33
    s_add_u32 s60, s60, 11534336
    s_lshl_b32 s33, s25, 13
    s_add_u32 s33, s33, 32768
    v_subrev_u32 v7, s33, v8
    s_lshl_b32 s33, s25, 7
    s_add_u32 s33, s33, 124
    v_lshl_add_u32 v5, v1, 9, s33
    s_mov_b32 s33, 0
    s_lshl_b32 s48, s25, 13
    s_lshl_b32 s45, s29, 15
    s_add_u32 s45, s45, s48
    s_setprio 2
    s_barrier
probe_32:
    buffer_load_dword v64, v5, s[8:11], s59 offen sc1
    s_waitcnt vmcnt(0)
    v_cmp_eq_u32 vcc, -1, v64
    s_nop 0
    s_cbranch_vccz px_33
    s_sub_u32 s58, s58, 1
    s_cbranch_scc0 probe_32
    s_mov_b32 s58, 0
px_33:
    s_barrier
    s_add_u32 s30, s59, 0
    s_add_u32 m0, s31, 0
    s_nop 0
    s_nop 0
    buffer_load_dwordx4 v12, s[8:11], s30 offen offset:0 sc1 lds
    buffer_load_dwordx4 v12, s[8:11], s30 offen offset:1024 sc1 lds
    buffer_load_dwordx4 v12, s[8:11], s30 offen offset:2048 sc1 lds
    buffer_load_dwordx4 v12, s[8:11], s30 offen offset:3072 sc1 lds
    s_add_u32 s30, s59, 4096
    s_add_u32 m0, s31, 4096
    s_nop 0
    s_nop 0
    buffer_load_dwordx4 v12, s[8:11], s30 offen offset:0 sc1 lds
    buffer_load_dwordx4 v12, s[8:11], s30 offen offset:1024 sc1 lds
    buffer_load_dwordx4 v12, s[8:11], s30 offen offset:2048 sc1 lds
    buffer_load_dwordx4 v12, s[8:11], s30 offen offset:3072 sc1 lds
    s_add_u32 s30, s59, 8192
    s_add_u32 m0, s48, 65536
    s_nop 0
    s_nop 0
    buffer_load_dwordx4 v12, s[8:11], s30 offen offset:0 sc1 lds
    buffer_load_dwordx4 v12, s[8:11], s30 offen offset:1024 sc1 lds
    buffer_load_dwordx4 v12, s[8:11], s30 offen offset:2048 sc1 lds
    buffer_load_dwordx4 v12, s[8:11], s30 offen offset:3072 sc1 lds
    s_add_u32 s30, s59, 12288
    s_add_u32 m0, s48, 69632
    s_nop 0
    buffer_load_dwordx4 v12, s[8:11], s30 offen offset:0 sc1 lds
    buffer_load_dwordx4 v12, s[8:11], s30 offen offset:1024 sc1 lds
    buffer_load_dwordx4 v12, s[8:11], s30 offen offset:2048 sc1 lds
    buffer_load_dwordx4 v12, s[8:11], s30 offen offset:3072 sc1 lds
    s_waitcnt vmcnt(12)
    ds_read_b64_tr_b16 v[32:33], v8 offset:0
    ds_read_b64_tr_b16 v[34:35], v8 offset:512
    ds_read_b64_tr_b16 v[36:37], v8 offset:1024
    ds_read_b64_tr_b16 v[38:39], v8 offset:1536
    ds_read_b64_tr_b16 v[40:41], v8 offset:2048
    ds_read_b64_tr_b16 v[42:43], v8 offset:2560
    ds_read_b64_tr_b16 v[44:45], v8 offset:3072
    ds_read_b64_tr_b16 v[46:47], v8 offset:3584
bk0_35:
    s_waitcnt lgkmcnt(0)
    v_or_b32 v4, 0xffff0000, v32
    v_and_b32 v32, v9, v32
    v_cmp_eq_u32 s[34:35], -1, v4
    s_nop 0
    v_mfma_f32_4x4x4_16b_bf16 v[48:51], v[32:33], v[32:33], 0
    v_mfma_f32_4x4x4_16b_bf16 v[52:55], v[34:35], v[34:35], 0
    s_nop 0
    v_mfma_f32_4x4x4_16b_bf16 v[48:51], v[36:37], v[36:37], v[48:51]
    v_mfma_f32_4x4x4_16b_bf16 v[52:55], v[38:39], v[38:39], v[52:55]
    s_nop 0
    v_mfma_f32_4x4x4_16b_bf16 v[48:51], v[40:41], v[40:41], v[48:51]
    v_mfma_f32_4x4x4_16b_bf16 v[52:55], v[42:43], v[42:43], v[52:55]
    s_nop 0
    v_mfma_f32_4x4x4_16b_bf16 v[48:51], v[44:45], v[44:45], v[48:51]
    v_mfma_f32_4x4x4_16b_bf16 v[52:55], v[46:47], v[46:47], v[52:55]
    s_waitcnt vmcnt(8)
    s_nop 0
    ds_read_b64_tr_b16 v[72:73], v8 offset:4096
    ds_read_b64_tr_b16 v[74:75], v8 offset:4608
    ds_read_b64_tr_b16 v[76:77], v8 offset:5120
    ds_read_b64_tr_b16 v[78:79], v8 offset:5632
    ds_read_b64_tr_b16 v[80:81], v8 offset:6144
    ds_read_b64_tr_b16 v[82:83], v8 offset:6656
    ds_read_b64_tr_b16 v[84:85], v8 offset:7168
    ds_read_b64_tr_b16 v[86:87], v8 offset:7680
    v_cmp_u_f32 vcc, v48, v52
    s_nop 0
    s_or_b64 vcc, vcc, s[34:35]
    s_cbranch_vccnz rty0_34
bk0_35_ok:
    s_barrier
    s_add_u32 s30, s59, 16384
    s_add_u32 m0, s31, 8192
    s_nop 0
    buffer_load_dwordx4 v12, s[8:11], s30 offen offset:0 sc1 lds
    buffer_load_dwordx4 v12, s[8:11], s30 offen offset:1024 sc1 lds
    buffer_load_dwordx4 v12, s[8:11], s30 offen offset:2048 sc1 lds
    buffer_load_dwordx4 v12, s[8:11], s30 offen offset:3072 sc1 lds
    s_add_u32 s30, s59, 20480
    s_add_u32 m0, s31, 12288
    s_nop 0
    buffer_load_dwordx4 v12, s[8:11], s30 offen offset:0 sc1 lds
    buffer_load_dwordx4 v12, s[8:11], s30 offen offset:1024 sc1 lds
    buffer_load_dwordx4 v12, s[8:11], s30 offen offset:2048 sc1 lds
    buffer_load_dwordx4 v12, s[8:11], s30 offen offset:3072 sc1 lds
bk1_37:
    s_waitcnt lgkmcnt(0)
    v_mfma_f32_4x4x4_16b_bf16 v[56:59], v[72:73], v[72:73], v[48:51]
    v_mfma_f32_4x4x4_16b_bf16 v[60:63], v[74:75], v[74:75], v[52:55]
    s_nop 0
    v_mfma_f32_4x4x4_16b_bf16 v[56:59], v[76:77], v[76:77], v[56:59]
    v_mfma_f32_4x4x4_16b_bf16 v[60:63], v[78:79], v[78:79], v[60:63]
    s_nop 0
    v_mfma_f32_4x4x4_16b_bf16 v[56:59], v[80:81], v[80:81], v[56:59]
    v_mfma_f32_4x4x4_16b_bf16 v[60:63], v[82:83], v[82:83], v[60:63]
    s_nop 0
    v_mfma_f32_4x4x4_16b_bf16 v[56:59], v[84:85], v[84:85], v[56:59]
    v_mfma_f32_4x4x4_16b_bf16 v[60:63], v[86:87], v[86:87], v[60:63]
    s_waitcnt vmcnt(12)
    ds_read_b64_tr_b16 v[32:33], v7 offset:0
    ds_read_b64_tr_b16 v[34:35], v7 offset:512
    ds_read_b64_tr_b16 v[36:37], v7 offset:1024
    ds_read_b64_tr_b16 v[38:39], v7 offset:1536
    ds_read_b64_tr_b16 v[40:41], v7 offset:2048
    ds_read_b64_tr_b16 v[42:43], v7 offset:2560
    ds_read_b64_tr_b16 v[44:45], v7 offset:3072
    ds_read_b64_tr_b16 v[46:47], v7 offset:3584
    v_cmp_u_f32 vcc, v56, v60
    s_nop 0
    s_cbranch_vccnz rty1_36
bk1_37_ok:
    s_barrier
    s_add_u32 s30, s59, 24576
    s_add_u32 m0, s31, 0
    s_nop 0
    buffer_load_dwordx4 v12, s[8:11], s30 offen offset:0 sc1 lds
    buffer_load_dwordx4 v12, s[8:11], s30 offen offset:1024 sc1 lds
    buffer_load_dwordx4 v12, s[8:11], s30 offen offset:2048 sc1 lds
    buffer_load_dwordx4 v12, s[8:11], s30 offen offset:3072 sc1 lds
bk2_39:
    s_waitcnt lgkmcnt(0)
    v_mfma_f32_4x4x4_16b_bf16 v[48:51], v[32:33], v[32:33], v[56:59]
    v_mfma_f32_4x4x4_16b_bf16 v[52:55], v[34:35], v[34:35], v[60:63]
    s_nop 0
    v_mfma_f32_4x4x4_16b_bf16 v[48:51], v[36:37], v[36:37], v[48:51]
    v_mfma_f32_4x4x4_16b_bf16 v[52:55], v[38:39], v[38:39], v[52:55]
    s_nop 0
    v_mfma_f32_4x4x4_16b_bf16 v[48:51], v[40:41], v[40:41], v[48:51]
    v_mfma_f32_4x4x4_16b_bf16 v[52:55], v[42:43], v[42:43], v[52:55]
    s_nop 0
    v_mfma_f32_4x4x4_16b_bf16 v[48:51], v[44:45], v[44:45], v[48:51]
    v_mfma_f32_4x4x4_16b_bf16 v[52:55], v[46:47], v[46:47], v[52:55]
    s_waitcnt vmcnt(12)
    s_nop 0
    ds_read_b64_tr_b16 v[72:73], v7 offset:4096
    ds_read_b64_tr_b16 v[74:75], v7 offset:4608
    ds_read_b64_tr_b16 v[76:77], v7 offset:5120
    ds_read_b64_tr_b16 v[78:79], v7 offset:5632
    ds_read_b64_tr_b16 v[80:81], v7 offset:6144
    ds_read_b64_tr_b16 v[82:83], v7 offset:6656
    ds_read_b64_tr_b16 v[84:85], v7 offset:7168
    ds_read_b64_tr_b16 v[86:87], v7 offset:7680
    v_cmp_u_f32 vcc, v48, v52
    s_nop 0
    s_cbranch_vccnz rty2_38
bk2_39_ok:
    s_barrier
    s_add_u32 s30, s59, 28672
    s_add_u32 m0, s31, 4096
    s_nop 0
    buffer_load_dwordx4 v12, s[8:11], s30 offen offset:0 sc1 lds
    buffer_load_dwordx4 v12, s[8:11], s30 offen offset:1024 sc1 lds
    buffer_load_dwordx4 v12, s[8:11], s30 offen offset:2048 sc1 lds
    buffer_load_dwordx4 v12, s[8:11], s30 offen offset:3072 sc1 lds
bk3_41:
    s_waitcnt lgkmcnt(0)
    v_mfma_f32_4x4x4_16b_bf16 v[56:59], v[72:73], v[72:73], v[48:51]
    v_mfma_f32_4x4x4_16b_bf16 v[60:63], v[74:75], v[74:75], v[52:55]
    s_nop 0
    v_mfma_f32_4x4x4_16b_bf16 v[56:59], v[76:77], v[76:77], v[56:59]
    v_mfma_f32_4x4x4_16b_bf16 v[60:63], v[78:79], v[78:79], v[60:63]
    s_nop 0
    v_mfma_f32_4x4x4_16b_bf16 v[56:59], v[80:81], v[80:81], v[56:59]
    v_mfma_f32_4x4x4_16b_bf16 v[60:63], v[82:83], v[82:83], v[60:63]
    s_nop 0
    v_mfma_f32_4x4x4_16b_bf16 v[56:59], v[84:85], v[84:85], v[56:59]
    v_mfma_f32_4x4x4_16b_bf16 v[60:63], v[86:87], v[86:87], v[60:63]
    s_waitcnt vmcnt(12)
    ds_read_b64_tr_b16 v[32:33], v8 offset:8192
    ds_read_b64_tr_b16 v[34:35], v8 offset:8704
    ds_read_b64_tr_b16 v[36:37], v8 offset:9216
    ds_read_b64_tr_b16 v[38:39], v8 offset:9728
    ds_read_b64_tr_b16 v[40:41], v8 offset:10240
    ds_read_b64_tr_b16 v[42:43], v8 offset:10752
    ds_read_b64_tr_b16 v[44:45], v8 offset:11264
    ds_read_b64_tr_b16 v[46:47], v8 offset:11776
    v_cmp_u_f32 vcc, v56, v60
    s_nop 0
    s_cbranch_vccnz rty3_40
bk3_41_ok:
    s_barrier
    v_and_b32 v4, 255, v0
    v_lshlrev_b32_e64 v4, 6, v4
    s_lshr_b32 s34, s2, 3
    s_lshl_b32 s34, s34, 14
    s_add_u32 s33, s34, 11534336
    buffer_load_dword v65, v4, s[8:11], s33 offen sc1
bk4_43:
    s_waitcnt lgkmcnt(0)
    v_mfma_f32_4x4x4_16b_bf16 v[48:51], v[32:33], v[32:33], v[56:59]
    v_mfma_f32_4x4x4_16b_bf16 v[52:55], v[34:35], v[34:35], v[60:63]
    s_nop 0
    v_mfma_f32_4x4x4_16b_bf16 v[48:51], v[36:37], v[36:37], v[48:51]
    v_mfma_f32_4x4x4_16b_bf16 v[52:55], v[38:39], v[38:39], v[52:55]
    s_nop 0
    v_mfma_f32_4x4x4_16b_bf16 v[48:51], v[40:41], v[40:41], v[48:51]
    v_mfma_f32_4x4x4_16b_bf16 v[52:55], v[42:43], v[42:43], v[52:55]
    s_nop 0
    v_mfma_f32_4x4x4_16b_bf16 v[48:51], v[44:45], v[44:45], v[48:51]
    v_mfma_f32_4x4x4_16b_bf16 v[52:55], v[46:47], v[46:47], v[52:55]
    s_waitcnt vmcnt(9)
    s_nop 0
    ds_read_b64_tr_b16 v[72:73], v8 offset:12288
    ds_read_b64_tr_b16 v[74:75], v8 offset:12800
    ds_read_b64_tr_b16 v[76:77], v8 offset:13312
    ds_read_b64_tr_b16 v[78:79], v8 offset:13824
    ds_read_b64_tr_b16 v[80:81], v8 offset:14336
    ds_read_b64_tr_b16 v[82:83], v8 offset:14848
    ds_read_b64_tr_b16 v[84:85], v8 offset:15360
    ds_read_b64_tr_b16 v[86:87], v8 offset:15872
    v_cmp_u_f32 vcc, v48, v52
    s_nop 0
    s_cbranch_vccnz rty4_42
bk4_43_ok:
    s_barrier
bk5_45:
    s_waitcnt lgkmcnt(0)
    v_mfma_f32_4x4x4_16b_bf16 v[56:59], v[72:73], v[72:73], v[48:51]
    v_mfma_f32_4x4x4_16b_bf16 v[60:63], v[74:75], v[74:75], v[52:55]
    s_nop 0
    v_mfma_f32_4x4x4_16b_bf16 v[56:59], v[76:77], v[76:77], v[56:59]
    v_mfma_f32_4x4x4_16b_bf16 v[60:63], v[78:79], v[78:79], v[60:63]
    s_nop 0
    v_mfma_f32_4x4x4_16b_bf16 v[56:59], v[80:81], v[80:81], v[56:59]
    v_mfma_f32_4x4x4_16b_bf16 v[60:63], v[82:83], v[82:83], v[60:63]
    s_nop 0
    v_mfma_f32_4x4x4_16b_bf16 v[56:59], v[84:85], v[84:85], v[56:59]
    v_mfma_f32_4x4x4_16b_bf16 v[60:63], v[86:87], v[86:87], v[60:63]
    s_waitcnt vmcnt(5)
    s_nop 0
    ds_read_b64_tr_b16 v[32:33], v8 offset:0
    ds_read_b64_tr_b16 v[34:35], v8 offset:512
    ds_read_b64_tr_b16 v[36:37], v8 offset:1024
    ds_read_b64_tr_b16 v[38:39], v8 offset:1536
    ds_read_b64_tr_b16 v[40:41], v8 offset:2048
    ds_read_b64_tr_b16 v[42:43], v8 offset:2560
    ds_read_b64_tr_b16 v[44:45], v8 offset:3072
    ds_read_b64_tr_b16 v[46:47], v8 offset:3584
    v_cmp_u_f32 vcc, v56, v60
    s_nop 0
    s_cbranch_vccnz rty5_44
bk5_45_ok:
    s_barrier
    s_add_u32 s30, s45, 9437184
    s_add_u32 m0, s48, 65536
    s_nop 0
    buffer_load_dwordx4 v6, s[8:11], s30 offen offset:0 sc1 lds
    buffer_load_dwordx4 v6, s[8:11], s30 offen offset:1024 sc1 lds
    buffer_load_dwordx4 v6, s[8:11], s30 offen offset:2048 sc1 lds
    buffer_load_dwordx4 v6, s[8:11], s30 offen offset:3072 sc1 lds
bk6_47:
    s_waitcnt lgkmcnt(0)
    v_mfma_f32_4x4x4_16b_bf16 v[48:51], v[32:33], v[32:33], v[56:59]
    v_mfma_f32_4x4x4_16b_bf16 v[52:55], v[34:35], v[34:35], v[60:63]
    s_nop 0
    v_mfma_f32_4x4x4_16b_bf16 v[48:51], v[36:37], v[36:37], v[48:51]
    v_mfma_f32_4x4x4_16b_bf16 v[52:55], v[38:39], v[38:39], v[52:55]
    s_nop 0
    v_mfma_f32_4x4x4_16b_bf16 v[48:51], v[40:41], v[40:41], v[48:51]
    v_mfma_f32_4x4x4_16b_bf16 v[52:55], v[42:43], v[42:43], v[52:55]
    s_nop 0
    v_mfma_f32_4x4x4_16b_bf16 v[48:51], v[44:45], v[44:45], v[48:51]
    v_mfma_f32_4x4x4_16b_bf16 v[52:55], v[46:47], v[46:47], v[52:55]
    s_waitcnt vmcnt(5)
    ds_read_b64_tr_b16 v[72:73], v8 offset:4096
    ds_read_b64_tr_b16 v[74:75], v8 offset:4608
    ds_read_b64_tr_b16 v[76:77], v8 offset:5120
    ds_read_b64_tr_b16 v[78:79], v8 offset:5632
    ds_read_b64_tr_b16 v[80:81], v8 offset:6144
    ds_read_b64_tr_b16 v[82:83], v8 offset:6656
    ds_read_b64_tr_b16 v[84:85], v8 offset:7168
    ds_read_b64_tr_b16 v[86:87], v8 offset:7680
    v_cmp_u_f32 vcc, v48, v52
    s_nop 0
    s_cbranch_vccnz rty6_46
bk6_47_ok:
    s_barrier
    s_add_u32 s30, s45, 9441280
    s_add_u32 m0, s48, 69632
    s_nop 0
    buffer_load_dwordx4 v6, s[8:11], s30 offen offset:0 sc1 lds
    buffer_load_dwordx4 v6, s[8:11], s30 offen offset:1024 sc1 lds
    buffer_load_dwordx4 v6, s[8:11], s30 offen offset:2048 sc1 lds
    buffer_load_dwordx4 v6, s[8:11], s30 offen offset:3072 sc1 lds
bk7_49:
    s_waitcnt lgkmcnt(0)
    v_mfma_f32_4x4x4_16b_bf16 v[56:59], v[72:73], v[72:73], v[48:51]
    v_mfma_f32_4x4x4_16b_bf16 v[60:63], v[74:75], v[74:75], v[52:55]
    s_nop 0
    v_mfma_f32_4x4x4_16b_bf16 v[56:59], v[76:77], v[76:77], v[56:59]
    v_mfma_f32_4x4x4_16b_bf16 v[60:63], v[78:79], v[78:79], v[60:63]
    s_nop 0
    v_mfma_f32_4x4x4_16b_bf16 v[56:59], v[80:81], v[80:81], v[56:59]
    v_mfma_f32_4x4x4_16b_bf16 v[60:63], v[82:83], v[82:83], v[60:63]
    s_nop 0
    v_mfma_f32_4x4x4_16b_bf16 v[56:59], v[84:85], v[84:85], v[56:59]
    v_mfma_f32_4x4x4_16b_bf16 v[60:63], v[86:87], v[86:87], v[60:63]
    s_nop 4
    v_cmp_u_f32 vcc, v56, v60
    s_nop 0
    s_cbranch_vccnz rty7_48
bk7_49_ok:
    s_barrier
    v_add_f32 v56, v56, v60
    v_add_f32 v57, v57, v61
    v_add_f32 v58, v58, v62
    v_add_f32 v59, v59, v63
    v_cndmask_b32 v56, v56, v57, s[38:39]
    v_cndmask_b32 v58, v58, v59, s[38:39]
    v_cndmask_b32 v15, v56, v58, s[4:5]
    v_mov_b32 v11, v15
    s_nop 1
    v_permlane32_swap_b32 v15, v11
    v_add_f32 v15, v15, v11
    v_mov_b32 v11, 0x3727c5ac
    v_fmac_f32 v11, 0x3b000000, v15
    v_rsq_f32_e64 v10, v11
    v_lshl_add_u32 v4, v2, 2, s31
    ds_write_b32 v4, v10 offset:14336
    s_waitcnt vmcnt(0)
    s_setprio 0
    s_waitcnt lgkmcnt(0)
    s_barrier
    s_cmp_eq_u32 s55, 0
    s_cbranch_scc1 hl1_50
    s_lshl_b32 s33, s29, 5
    s_lshr_b32 s34, s25, 1
    s_lshl_b32 s34, s34, 4
    s_add_u32 s33, s33, s34
    v_add_u32 v4, s33, v13
    v_and_b32 v5, 1, v4
    v_cvt_f32_u32_e64 v4, v4
    v_mul_f32 v4, 0x3b000000, v4
    s_and_b32 s34, s25, 1
    s_lshl_b32 s33, s34, 7
    v_lshl_add_u32 v7, v14, 1, s33
    v_cvt_f32_u32 v7, v7
    v_mul_f32 v7, v7, v4
    v_mul_f32 v8, 0x41800000, v4
    v_cos_f32_e64 v11, v8
    v_mul_f32 v8, 0x40e00000, v4
    v_add_f32 v11, v11, v11
    v_cos_f32 v32, v7
    v_sin_f32 v33, v7
    v_add_f32 v7, v4, v7
    v_cos_f32 v34, v7
    v_sin_f32 v35, v7
    v_add_f32 v7, v8, v7
    v_cos_f32 v36, v7
    v_sin_f32 v37, v7
    v_add_f32 v7, v4, v7
    v_cos_f32 v38, v7
    v_sin_f32 v39, v7
    v_add_f32 v7, v8, v7
    v_cos_f32 v40, v7
    v_sin_f32 v41, v7
    v_add_f32 v7, v4, v7
    v_cos_f32 v42, v7
    v_sin_f32 v43, v7
    v_add_f32 v7, v8, v7
    v_cos_f32 v44, v7
    v_sin_f32 v45, v7
    v_add_f32 v7, v4, v7
    v_cos_f32 v46, v7
    v_sin_f32 v47, v7
    v_mov_b32 v8, 0x3d800000
    v_mov_b32 v9, 0xbd800000
    v_pk_mul_f32 v[32:33], v[32:33], v[8:9]
    v_pk_mul_f32 v[34:35], v[34:35], v[8:9]
    v_pk_mul_f32 v[36:37], v[36:37], v[8:9]
    v_pk_mul_f32 v[38:39], v[38:39], v[8:9]
    v_pk_mul_f32 v[40:41], v[40:41], v[8:9]
    v_pk_mul_f32 v[42:43], v[42:43], v[8:9]
    v_pk_mul_f32 v[44:45], v[44:45], v[8:9]
    v_pk_mul_f32 v[46:47], v[46:47], v[8:9]
    v_add_u32 v10, s48, v6
    v_lshlrev_b32 v5, 31, v5
    v_or_b32 v5, 1026899253, v5
    v_or_b32 v7, s34, v14
    v_cmp_eq_u32 vcc, 0, v7
    v_cvt_pk_bf16_f32 v48, v32, v33
    v_cvt_pk_bf16_f32 v49, v34, v35
    v_cvt_pk_bf16_f32 v50, v36, v37
    v_cvt_pk_bf16_f32 v51, v38, v39
    v_cndmask_b32 v48, v48, v5, vcc
    s_nop 0
    ds_write_b128 v10, v[48:51] offset:0
    v_cvt_pk_bf16_f32 v52, v40, v41
    v_cvt_pk_bf16_f32 v53, v42, v43
    v_cvt_pk_bf16_f32 v54, v44, v45
    v_cvt_pk_bf16_f32 v55, v46, v47
    ds_write_b128 v10, v[52:55] offset:1024
    v_fma_f32 v32, v11, v40, -v32
    v_fma_f32 v33, v11, v41, -v33
    v_fma_f32 v34, v11, v42, -v34
    v_fma_f32 v35, v11, v43, -v35
    v_fma_f32 v36, v11, v44, -v36
    v_fma_f32 v37, v11, v45, -v37
    v_fma_f32 v38, v11, v46, -v38
    v_fma_f32 v39, v11, v47, -v39
    v_cvt_pk_bf16_f32 v48, v32, v33
    v_cvt_pk_bf16_f32 v49, v34, v35
    v_cvt_pk_bf16_f32 v50, v36, v37
    v_cvt_pk_bf16_f32 v51, v38, v39
    ds_write_b128 v10, v[48:51] offset:2048
    v_fma_f32 v40, v11, v32, -v40
    v_fma_f32 v41, v11, v33, -v41
    v_fma_f32 v42, v11, v34, -v42
    v_fma_f32 v43, v11, v35, -v43
    v_fma_f32 v44, v11, v36, -v44
    v_fma_f32 v45, v11, v37, -v45
    v_fma_f32 v46, v11, v38, -v46
    v_fma_f32 v47, v11, v39, -v47
    v_cvt_pk_bf16_f32 v52, v40, v41
    v_cvt_pk_bf16_f32 v53, v42, v43
    v_cvt_pk_bf16_f32 v54, v44, v45
    v_cvt_pk_bf16_f32 v55, v46, v47
    ds_write_b128 v10, v[52:55] offset:3072
    v_fma_f32 v32, v11, v40, -v32
    v_fma_f32 v33, v11, v41, -v33
    v_fma_f32 v34, v11, v42, -v34
    v_fma_f32 v35, v11, v43, -v35
    v_fma_f32 v36, v11, v44, -v36
    v_fma_f32 v37, v11, v45, -v37
    v_fma_f32 v38, v11, v46, -v38
    v_fma_f32 v39, v11, v47, -v39
    v_cvt_pk_bf16_f32 v48, v32, v33
    v_cvt_pk_bf16_f32 v49, v34, v35
    v_cvt_pk_bf16_f32 v50, v36, v37
    v_cvt_pk_bf16_f32 v51, v38, v39
    ds_write_b128 v10, v[48:51] offset:4096
    v_fma_f32 v40, v11, v32, -v40
    v_fma_f32 v41, v11, v33, -v41
    v_fma_f32 v42, v11, v34, -v42
    v_fma_f32 v43, v11, v35, -v43
    v_fma_f32 v44, v11, v36, -v44
    v_fma_f32 v45, v11, v37, -v45
    v_fma_f32 v46, v11, v38, -v46
    v_fma_f32 v47, v11, v39, -v47
    v_cvt_pk_bf16_f32 v52, v40, v41
    v_cvt_pk_bf16_f32 v53, v42, v43
    v_cvt_pk_bf16_f32 v54, v44, v45
    v_cvt_pk_bf16_f32 v55, v46, v47
    ds_write_b128 v10, v[52:55] offset:5120
    v_fma_f32 v32, v11, v40, -v32
    v_fma_f32 v33, v11, v41, -v33
    v_fma_f32 v34, v11, v42, -v34
    v_fma_f32 v35, v11, v43, -v35
    v_fma_f32 v36, v11, v44, -v36
    v_fma_f32 v37, v11, v45, -v37
    v_fma_f32 v38, v11, v46, -v38
    v_fma_f32 v39, v11, v47, -v39
    v_cvt_pk_bf16_f32 v48, v32, v33
    v_cvt_pk_bf16_f32 v49, v34, v35
    v_cvt_pk_bf16_f32 v50, v36, v37
    v_cvt_pk_bf16_f32 v51, v38, v39
    ds_write_b128 v10, v[48:51] offset:6144
    v_fma_f32 v40, v11, v32, -v40
    v_fma_f32 v41, v11, v33, -v41
    v_fma_f32 v42, v11, v34, -v42
    v_fma_f32 v43, v11, v35, -v43
    v_fma_f32 v44, v11, v36, -v44
    v_fma_f32 v45, v11, v37, -v45
    v_fma_f32 v46, v11, v38, -v46
    v_fma_f32 v47, v11, v39, -v47
    v_cvt_pk_bf16_f32 v52, v40, v41
    v_cvt_pk_bf16_f32 v53, v42, v43
    v_cvt_pk_bf16_f32 v54, v44, v45
    v_cvt_pk_bf16_f32 v55, v46, v47
    ds_write_b128 v10, v[52:55] offset:7168
    s_waitcnt lgkmcnt(0)
    s_branch hl1_50_j
hl1_50:
    buffer_load_dwordx4 v[192:195], v6, s[8:11], s60 offen offset:0 sc1
    buffer_load_dwordx4 v[196:199], v6, s[8:11], s60 offen offset:1024 sc1
    s_add_u32 s60, s60, 2048
    buffer_load_dwordx4 v[200:203], v6, s[8:11], s60 offen offset:0 sc1
    buffer_load_dwordx4 v[204:207], v6, s[8:11], s60 offen offset:1024 sc1
    s_add_u32 s60, s60, 2048
    buffer_load_dwordx4 v[208:211], v6, s[8:11], s60 offen offset:0 sc1
    buffer_load_dwordx4 v[212:215], v6, s[8:11], s60 offen offset:1024 sc1
    s_add_u32 s60, s60, 2048
    buffer_load_dwordx4 v[216:219], v6, s[8:11], s60 offen offset:0 sc1
    buffer_load_dwordx4 v[220:223], v6, s[8:11], s60 offen offset:1024 sc1
    s_add_u32 s60, s60, 2048
    buffer_load_dwordx4 v[224:227], v6, s[8:11], s60 offen offset:0 sc1
    buffer_load_dwordx4 v[228:231], v6, s[8:11], s60 offen offset:1024 sc1
    s_add_u32 s60, s60, 2048
    buffer_load_dwordx4 v[232:235], v6, s[8:11], s60 offen offset:0 sc1
    buffer_load_dwordx4 v[236:239], v6, s[8:11], s60 offen offset:1024 sc1
    s_add_u32 s60, s60, 2048
    buffer_load_dwordx4 v[240:243], v6, s[8:11], s60 offen offset:0 sc1
    buffer_load_dwordx4 v[244:247], v6, s[8:11], s60 offen offset:1024 sc1
    s_add_u32 s60, s60, 2048
    buffer_load_dwordx4 v[248:251], v6, s[8:11], s60 offen offset:0 sc1
    buffer_load_dwordx4 v[252:255], v6, s[8:11], s60 offen offset:1024 sc1
    s_add_u32 s60, s60, 2048
hl1_50_j:
    s_lshl_b32 s45, s26, 10
    v_add_u32 v8, s45, v6
    v_and_b32 v9, 47, v1
    v_lshlrev_b32_e64 v9, 4, v9
    s_lshl_b32 s45, s26, 8
    s_add_u32 s45, s45, 2048
    v_add_u32_e64 v9, s45, v9
    v_mov_b32 v72, 0x3f803f80
    v_mov_b32 v73, 0x3f803f80
    v_mov_b32 v74, 0x3f803f80
    v_mov_b32 v75, 0x3f803f80
    v_mov_b32 v76, 0x3f803f80
    v_mov_b32 v77, 0x3f803f80
    v_mov_b32 v78, 0x3f803f80
    v_mov_b32 v79, 0x3f803f80
    v_mov_b32 v80, 0x3f803f80
    v_mov_b32 v81, 0x3f803f80
    v_mov_b32 v82, 0x3f803f80
    v_mov_b32 v83, 0x3f803f80
    v_mov_b32 v84, 0x3f803f80
    v_mov_b32 v85, 0x3f803f80
    v_mov_b32 v86, 0x3f803f80
    v_mov_b32 v87, 0x3f803f80
    s_mov_b32 s38, 0xffff
    s_mov_b32 s39, 0xffff
    s_lshl_b32 s60, s57, 3
    s_add_u32 s60, s60, s24
    s_lshl_b32 s45, s60, 10
    s_lshl_b32 s60, s60, 14
    s_lshl_b32 s48, s55, 19
    s_add_u32 s60, s60, s48
    s_add_u32 s60, s60, 11534336
    s_lshl_b32 s48, s56, 15
    s_add_u32 s45, s45, s48
    s_add_u32 s43, s45, s51
    v_add_u32 v20, s40, v8
    v_add_u32 v21, s40, v9
    v_add_u32 v22, s42, v8
    v_add_u32 v23, s42, v9
    v_add_u32_e64 v7, s40, v6
    s_barrier
    ds_read_b128 v[16:19], v7 offset:4096
attn_19:
    v_add_u32 v12, 4096, v6
    s_cmp_lt_u32 s24, 4
    s_cbranch_scc1 nofetch_52
    s_cmp_ge_u32 s63, 2
    s_cbranch_scc1 nofetch_52
    s_setprio 2
    s_cmp_le_u32 s28, s63
    s_cbranch_scc1 nofetch_52_p
    s_sub_u32 s30, 1, s63
    s_lshl_b32 s35, s28, 4
    s_add_u32 s35, s35, s29
    s_lshl_b32 s35, s35, 9
    s_lshl_b32 s34, s30, 8
    s_add_u32 s35, s35, s34
    s_lshl_b32 s34, s55, 17
    s_add_u32 s35, s35, s34
    s_add_u32 s35, s35, 33554432
    v_and_b32 v4, 3, v1
    v_lshlrev_b32_e64 v4, 6, v4
    s_add_u32 s32, s28, s30
    s_sub_u32 s32, s32, 2
    s_lshl_b32 s32, s32, 2
    s_lshl_b32 s33, s29, 6
    s_add_u32 s32, s32, s33
    s_lshl_b32 s32, s32, 12
    s_add_u32 s32, s32, s53
    s_lshl_b32 s33, s30, 14
    s_add_u32 s33, s33, 131072
hpoll_53:
    buffer_load_dword v5, v4, s[8:11], s35 offen sc1
    s_waitcnt vmcnt(0)
    v_cmp_ne_u32 vcc, s36, v5
    s_nop 0
    s_cbranch_vccz px_54
    s_sub_u32 s58, s58, 1
    s_cbranch_scc0 hpoll_53
    s_mov_b32 s58, 0
px_54:
    s_add_u32 m0, s33, 0
    s_nop 0
    s_nop 0
    buffer_load_dwordx4 v6, s[8:11], s32 offen offset:0 sc1 lds
    buffer_load_dwordx4 v6, s[8:11], s32 offen offset:1024 sc1 lds
    buffer_load_dwordx4 v6, s[8:11], s32 offen offset:2048 sc1 lds
    buffer_load_dwordx4 v6, s[8:11], s32 offen offset:3072 sc1 lds
    s_add_u32 s32, s32, 4096
    s_add_u32 m0, s33, 4096
    s_nop 0
    s_nop 0
    buffer_load_dwordx4 v6, s[8:11], s32 offen offset:0 sc1 lds
    buffer_load_dwordx4 v6, s[8:11], s32 offen offset:1024 sc1 lds
    buffer_load_dwordx4 v6, s[8:11], s32 offen offset:2048 sc1 lds
    buffer_load_dwordx4 v6, s[8:11], s32 offen offset:3072 sc1 lds
    s_add_u32 s32, s32, 4096
    s_add_u32 m0, s33, 8192
    s_nop 0
    s_nop 0
    buffer_load_dwordx4 v6, s[8:11], s32 offen offset:0 sc1 lds
    buffer_load_dwordx4 v6, s[8:11], s32 offen offset:1024 sc1 lds
    buffer_load_dwordx4 v6, s[8:11], s32 offen offset:2048 sc1 lds
    buffer_load_dwordx4 v6, s[8:11], s32 offen offset:3072 sc1 lds
    s_add_u32 s32, s32, 4096
    s_add_u32 m0, s33, 12288
    s_nop 0
    buffer_load_dwordx4 v6, s[8:11], s32 offen offset:0 sc1 lds
    buffer_load_dwordx4 v6, s[8:11], s32 offen offset:1024 sc1 lds
    buffer_load_dwordx4 v6, s[8:11], s32 offen offset:2048 sc1 lds
    buffer_load_dwordx4 v6, s[8:11], s32 offen offset:3072 sc1 lds
nofetch_52_p:
    s_setprio 0
nofetch_52:
    v_subrev_u32 v20, 24576, v20
    v_subrev_u32 v21, 24576, v21
    ds_read_b128 v[88:91], v20 offset:24576
    ds_read_b128 v[92:95], v20 offset:16384
    s_mov_b64 exec, s[38:39]
    ds_read_b128 v[72:75], v21 offset:24576
    ds_read_b128 v[76:79], v21 offset:25600
    s_mov_b64 exec, -1
    s_waitcnt lgkmcnt(3)
    v_mfma_f32_32x32x16_bf16 v[32:47], v[88:91], v[16:19], v[96:111]
    s_waitcnt lgkmcnt(2)
    v_mfma_f32_32x32x16_bf16 v[48:63], v[92:95], v[16:19], 0
    ds_read_b128 v[88:91], v20 offset:8192
    s_nop 8
    v_exp_f32 v32, v32
    v_exp_f32 v33, v33
    v_exp_f32 v34, v34
    v_exp_f32 v35, v35
    v_exp_f32 v36, v36
    v_exp_f32 v37, v37
    v_exp_f32 v38, v38
    v_exp_f32 v39, v39
    s_mov_b64 exec, s[38:39]
    ds_read_b128 v[80:83], v21 offset:16384
    ds_read_b128 v[84:87], v21 offset:17408
    s_mov_b64 exec, -1
    v_cvt_pk_bf16_f32 v64, v32, v33
    v_cvt_pk_bf16_f32 v65, v34, v35
    v_cvt_pk_bf16_f32 v66, v36, v37
    v_cvt_pk_bf16_f32 v67, v38, v39
    v_exp_f32 v40, v40
    v_exp_f32 v41, v41
    v_exp_f32_e64 v42, v42
    s_waitcnt lgkmcnt(3)
    v_mfma_f32_32x32x16_bf16 v[112:127], v[72:75], v[64:67], 0
    v_exp_f32 v43, v43
    v_exp_f32 v44, v44
    v_exp_f32 v45, v45
    v_exp_f32 v46, v46
    v_exp_f32_e64 v47, v47
    v_cvt_pk_bf16_f32 v68, v40, v41
    v_cvt_pk_bf16_f32 v69, v42, v43
    v_cvt_pk_bf16_f32 v70, v44, v45
    v_cvt_pk_bf16_f32 v71, v46, v47
    s_cmp_eq_u32 s63, 0
    s_cbranch_scc1 ex0_56
    s_waitcnt lgkmcnt(0)
    v_mfma_f32_32x32x16_bf16 v[32:47], v[88:91], v[16:19], 0
    ds_read_b128 v[92:95], v20 offset:0
    v_exp_f32 v48, v48
    v_exp_f32 v49, v49
    v_exp_f32 v50, v50
    v_exp_f32 v51, v51
    v_exp_f32 v52, v52
    v_mfma_f32_32x32x16_bf16 v[112:127], v[76:79], v[68:71], v[112:127]
    v_exp_f32 v53, v53
    v_exp_f32 v54, v54
    v_exp_f32 v55, v55
    s_mov_b64 exec, s[38:39]
    ds_read_b128 v[72:75], v21 offset:8192
    ds_read_b128 v[76:79], v21 offset:9216
    s_mov_b64 exec, -1
    v_cvt_pk_bf16_f32 v64, v48, v49
    v_cvt_pk_bf16_f32 v65, v50, v51
    v_cvt_pk_bf16_f32 v66, v52, v53
    v_cvt_pk_bf16_f32 v67, v54, v55
    v_exp_f32 v56, v56
    v_exp_f32 v57, v57
    v_exp_f32 v58, v58
    v_mfma_f32_32x32x16_bf16 v[112:127], v[80:83], v[64:67], v[112:127]
    v_exp_f32 v59, v59
    v_exp_f32 v60, v60
    v_exp_f32 v61, v61
    v_exp_f32 v62, v62
    v_exp_f32_e64 v63, v63
    v_cvt_pk_bf16_f32 v68, v56, v57
    v_cvt_pk_bf16_f32 v69, v58, v59
    v_cvt_pk_bf16_f32 v70, v60, v61
    v_cvt_pk_bf16_f32 v71, v62, v63
    s_cmp_eq_u32 s63, 1
    s_cbranch_scc1 ex1_57
    s_waitcnt lgkmcnt(0)
    v_mfma_f32_32x32x16_bf16 v[48:63], v[92:95], v[16:19], 0
    v_exp_f32 v32, v32
    v_exp_f32 v33, v33
    v_exp_f32 v34, v34
    v_exp_f32 v35, v35
    v_exp_f32 v36, v36
    v_mfma_f32_32x32x16_bf16 v[112:127], v[84:87], v[68:71], v[112:127]
    v_exp_f32 v37, v37
    v_exp_f32 v38, v38
    v_exp_f32 v39, v39
    s_mov_b64 exec, s[38:39]
    ds_read_b128 v[80:83], v21 offset:0
    ds_read_b128 v[84:87], v21 offset:1024
    s_mov_b64 exec, -1
    v_cvt_pk_bf16_f32 v64, v32, v33
    v_cvt_pk_bf16_f32 v65, v34, v35
    v_cvt_pk_bf16_f32 v66, v36, v37
    v_cvt_pk_bf16_f32 v67, v38, v39
    v_exp_f32 v40, v40
    v_exp_f32 v41, v41
    v_exp_f32 v42, v42
    v_mfma_f32_32x32x16_bf16 v[112:127], v[72:75], v[64:67], v[112:127]
    v_exp_f32 v43, v43
    v_exp_f32 v44, v44
    v_exp_f32 v45, v45
    v_exp_f32 v46, v46
    v_exp_f32_e64 v47, v47
    v_cvt_pk_bf16_f32 v68, v40, v41
    v_cvt_pk_bf16_f32 v69, v42, v43
    v_cvt_pk_bf16_f32 v70, v44, v45
    v_cvt_pk_bf16_f32 v71, v46, v47
    s_cmp_eq_u32 s63, 2
    s_cbranch_scc1 ex2_58
    v_exp_f32 v48, v48
    v_exp_f32 v49, v49
    v_exp_f32 v50, v50
    v_exp_f32 v51, v51
    v_exp_f32_e64 v52, v52
    v_mfma_f32_32x32x16_bf16 v[112:127], v[76:79], v[68:71], v[112:127]
    v_exp_f32 v53, v53
    v_exp_f32 v54, v54
    v_exp_f32_e64 v55, v55
    v_cvt_pk_bf16_f32 v64, v48, v49
    v_cvt_pk_bf16_f32 v65, v50, v51
    v_cvt_pk_bf16_f32 v66, v52, v53
    v_cvt_pk_bf16_f32 v67, v54, v55
    v_exp_f32 v56, v56
    v_exp_f32 v57, v57
    v_exp_f32 v58, v58
    s_waitcnt lgkmcnt(0)
    v_mfma_f32_32x32x16_bf16 v[112:127], v[80:83], v[64:67], v[112:127]
    v_exp_f32 v59, v59
    v_exp_f32 v60, v60
    v_exp_f32 v61, v61
    v_exp_f32 v62, v62
    v_exp_f32_e64 v63, v63
    v_cvt_pk_bf16_f32 v68, v56, v57
    v_cvt_pk_bf16_f32 v69, v58, v59
    v_cvt_pk_bf16_f32 v70, v60, v61
    v_cvt_pk_bf16_f32 v71, v62, v63
    s_nop 1
    v_mfma_f32_32x32x16_bf16 v[112:127], v[84:87], v[68:71], v[112:127]
adone_55:
    s_mov_b32 m0, s61
    s_nop 0
    buffer_load_dwordx4 v6, s[8:11], s43 offen sc1 lds
    s_cmp_ge_u32 s24, 4
    s_cbranch_scc1 midh_65
    s_cmp_eq_u32 s55, 0
    s_cbranch_scc1 mid_64
    ds_read_b128 v[32:35], v6 offset:0
    ds_read_b128 v[36:39], v6 offset:16384
    ds_read_b128 v[40:43], v6 offset:1024
    ds_read_b128 v[44:47], v6 offset:17408
    s_waitcnt lgkmcnt(2)
    v_mfma_f32_16x16x32_bf16 v[48:51], v[32:35], v[128:131], 0
    ds_read_b128 v[64:67], v6 offset:2048
    ds_read_b128 v[68:71], v6 offset:18432
    v_mfma_f32_16x16x32_bf16 v[52:55], v[32:35], v[132:135], 0
    v_mfma_f32_16x16x32_bf16 v[56:59], v[36:39], v[128:131], 0
    v_mfma_f32_16x16x32_bf16 v[60:63], v[36:39], v[132:135], 0
    s_waitcnt lgkmcnt(2)
    s_nop 0
    v_mfma_f32_16x16x32_bf16 v[48:51], v[40:43], v[136:139], v[48:51]
    ds_read_b128 v[32:35], v6 offset:3072
    ds_read_b128 v[36:39], v6 offset:19456
    v_mfma_f32_16x16x32_bf16 v[52:55], v[40:43], v[140:143], v[52:55]
    v_mfma_f32_16x16x32_bf16 v[56:59], v[44:47], v[136:139], v[56:59]
    v_mfma_f32_16x16x32_bf16 v[60:63], v[44:47], v[140:143], v[60:63]
    s_waitcnt lgkmcnt(2)
    s_nop 0
    v_mfma_f32_16x16x32_bf16 v[48:51], v[64:67], v[144:147], v[48:51]
    ds_read_b128 v[40:43], v6 offset:4096
    ds_read_b128 v[44:47], v6 offset:20480
    v_mfma_f32_16x16x32_bf16 v[52:55], v[64:67], v[148:151], v[52:55]
    v_mfma_f32_16x16x32_bf16 v[56:59], v[68:71], v[144:147], v[56:59]
    v_mfma_f32_16x16x32_bf16 v[60:63], v[68:71], v[148:151], v[60:63]
    s_waitcnt lgkmcnt(2)
    s_nop 0
    v_mfma_f32_16x16x32_bf16 v[48:51], v[32:35], v[152:155], v[48:51]
    ds_read_b128 v[64:67], v6 offset:5120
    ds_read_b128 v[68:71], v6 offset:21504
    v_mfma_f32_16x16x32_bf16 v[52:55], v[32:35], v[156:159], v[52:55]
    v_mfma_f32_16x16x32_bf16 v[56:59], v[36:39], v[152:155], v[56:59]
    v_mfma_f32_16x16x32_bf16 v[60:63], v[36:39], v[156:159], v[60:63]
    s_waitcnt lgkmcnt(2)
    s_nop 0
    v_mfma_f32_16x16x32_bf16 v[48:51], v[40:43], v[160:163], v[48:51]
    ds_read_b128 v[32:35], v6 offset:6144
    ds_read_b128 v[36:39], v6 offset:22528
    v_mfma_f32_16x16x32_bf16 v[52:55], v[40:43], v[164:167], v[52:55]
    v_mfma_f32_16x16x32_bf16 v[56:59], v[44:47], v[160:163], v[56:59]
    v_mfma_f32_16x16x32_bf16 v[60:63], v[44:47], v[164:167], v[60:63]
    s_waitcnt lgkmcnt(2)
    s_nop 0
    v_mfma_f32_16x16x32_bf16 v[48:51], v[64:67], v[168:171], v[48:51]
    ds_read_b128 v[40:43], v6 offset:7168
    ds_read_b128 v[44:47], v6 offset:23552
    v_mfma_f32_16x16x32_bf16 v[52:55], v[64:67], v[172:175], v[52:55]
    v_mfma_f32_16x16x32_bf16 v[56:59], v[68:71], v[168:171], v[56:59]
    v_mfma_f32_16x16x32_bf16 v[60:63], v[68:71], v[172:175], v[60:63]
    s_waitcnt lgkmcnt(2)
    s_nop 0
    v_mfma_f32_16x16x32_bf16 v[48:51], v[32:35], v[176:179], v[48:51]
    ds_read_b128 v[64:67], v6 offset:8192
    ds_read_b128 v[68:71], v6 offset:24576
    v_mfma_f32_16x16x32_bf16 v[52:55], v[32:35], v[180:183], v[52:55]
    v_mfma_f32_16x16x32_bf16 v[56:59], v[36:39], v[176:179], v[56:59]
    v_mfma_f32_16x16x32_bf16 v[60:63], v[36:39], v[180:183], v[60:63]
    s_waitcnt lgkmcnt(2)
    s_nop 0
    v_mfma_f32_16x16x32_bf16 v[48:51], v[40:43], v[184:187], v[48:51]
    ds_read_b128 v[32:35], v6 offset:9216
    ds_read_b128 v[36:39], v6 offset:25600
    v_mfma_f32_16x16x32_bf16 v[52:55], v[40:43], v[188:191], v[52:55]
    v_mfma_f32_16x16x32_bf16 v[56:59], v[44:47], v[184:187], v[56:59]
    v_mfma_f32_16x16x32_bf16 v[60:63], v[44:47], v[188:191], v[60:63]
    s_waitcnt lgkmcnt(2)
    s_nop 0
    v_mfma_f32_16x16x32_bf16 v[48:51], v[64:67], v[192:195], v[48:51]
    ds_read_b128 v[40:43], v6 offset:10240
    ds_read_b128 v[44:47], v6 offset:26624
    v_mfma_f32_16x16x32_bf16 v[52:55], v[64:67], v[196:199], v[52:55]
    v_mfma_f32_16x16x32_bf16 v[56:59], v[68:71], v[192:195], v[56:59]
    v_mfma_f32_16x16x32_bf16 v[60:63], v[68:71], v[196:199], v[60:63]
    s_waitcnt lgkmcnt(2)
    s_nop 0
    v_mfma_f32_16x16x32_bf16 v[48:51], v[32:35], v[200:203], v[48:51]
    ds_read_b128 v[64:67], v6 offset:11264
    ds_read_b128 v[68:71], v6 offset:27648
    v_mfma_f32_16x16x32_bf16 v[52:55], v[32:35], v[204:207], v[52:55]
    v_mfma_f32_16x16x32_bf16 v[56:59], v[36:39], v[200:203], v[56:59]
    v_mfma_f32_16x16x32_bf16 v[60:63], v[36:39], v[204:207], v[60:63]
    s_waitcnt lgkmcnt(2)
    s_nop 0
    v_mfma_f32_16x16x32_bf16 v[48:51], v[40:43], v[208:211], v[48:51]
    ds_read_b128 v[32:35], v6 offset:12288
    ds_read_b128 v[36:39], v6 offset:28672
    v_mfma_f32_16x16x32_bf16 v[52:55], v[40:43], v[212:215], v[52:55]
    v_mfma_f32_16x16x32_bf16 v[56:59], v[44:47], v[208:211], v[56:59]
    v_mfma_f32_16x16x32_bf16 v[60:63], v[44:47], v[212:215], v[60:63]
    s_waitcnt lgkmcnt(2)
    s_nop 0
    v_mfma_f32_16x16x32_bf16 v[48:51], v[64:67], v[216:219], v[48:51]
    ds_read_b128 v[40:43], v6 offset:13312
    ds_read_b128 v[44:47], v6 offset:29696
    v_mfma_f32_16x16x32_bf16 v[52:55], v[64:67], v[220:223], v[52:55]
    v_mfma_f32_16x16x32_bf16 v[56:59], v[68:71], v[216:219], v[56:59]
    v_mfma_f32_16x16x32_bf16 v[60:63], v[68:71], v[220:223], v[60:63]
    s_waitcnt lgkmcnt(2)
    s_nop 0
    v_mfma_f32_16x16x32_bf16 v[48:51], v[32:35], v[224:227], v[48:51]
    ds_read_b128 v[64:67], v6 offset:14336
    ds_read_b128 v[68:71], v6 offset:30720
    v_mfma_f32_16x16x32_bf16 v[52:55], v[32:35], v[228:231], v[52:55]
    v_mfma_f32_16x16x32_bf16 v[56:59], v[36:39], v[224:227], v[56:59]
    v_mfma_f32_16x16x32_bf16 v[60:63], v[36:39], v[228:231], v[60:63]
    s_waitcnt lgkmcnt(2)
    s_nop 0
    v_mfma_f32_16x16x32_bf16 v[48:51], v[40:43], v[232:235], v[48:51]
    ds_read_b128 v[32:35], v6 offset:15360
    ds_read_b128 v[36:39], v6 offset:31744
    v_mfma_f32_16x16x32_bf16 v[52:55], v[40:43], v[236:239], v[52:55]
    v_mfma_f32_16x16x32_bf16 v[56:59], v[44:47], v[232:235], v[56:59]
    v_mfma_f32_16x16x32_bf16 v[60:63], v[44:47], v[236:239], v[60:63]
    s_waitcnt lgkmcnt(2)
    v_mfma_f32_16x16x32_bf16 v[48:51], v[64:67], v[240:243], v[48:51]
    v_mfma_f32_16x16x32_bf16 v[52:55], v[64:67], v[244:247], v[52:55]
    v_mfma_f32_16x16x32_bf16 v[56:59], v[68:71], v[240:243], v[56:59]
    v_mfma_f32_16x16x32_bf16 v[60:63], v[68:71], v[244:247], v[60:63]
    s_waitcnt lgkmcnt(0)
    v_mfma_f32_16x16x32_bf16 v[48:51], v[32:35], v[248:251], v[48:51]
    v_mfma_f32_16x16x32_bf16 v[52:55], v[32:35], v[252:255], v[52:55]
    v_mfma_f32_16x16x32_bf16 v[56:59], v[36:39], v[248:251], v[56:59]
    v_mfma_f32_16x16x32_bf16 v[60:63], v[36:39], v[252:255], v[60:63]
    s_lshl_b32 s32, s27, 15
    s_lshl_b32 s33, s29, 11
    s_add_u32 s32, s32, s33
    s_add_u32 s32, s32, 29360128
    v_lshlrev_b32 v4, 5, v13
    v_lshl_or_b32 v4, v14, 3, v4
    v_cvt_pk_bf16_f32 v48, v48, v49
    v_cvt_pk_bf16_f32 v49, v50, v51
    v_cvt_pk_bf16_f32 v50, v52, v53
    v_cvt_pk_bf16_f32 v51, v54, v55
    v_cvt_pk_bf16_f32 v52, v56, v57
    v_cvt_pk_bf16_f32 v53, v58, v59
    v_cvt_pk_bf16_f32 v54, v60, v61
    v_cvt_pk_bf16_f32 v55, v62, v63
    buffer_store_dwordx2 v[48:49], v4, s[8:11], s32 offen offset:0 sc1
    buffer_store_dwordx2 v[50:51], v4, s[8:11], s32 offen offset:512 sc1
    buffer_store_dwordx2 v[52:53], v4, s[8:11], s32 offen offset:1024 sc1
    buffer_store_dwordx2 v[54:55], v4, s[8:11], s32 offen offset:1536 sc1
    s_branch mid_64
midh_65:
    s_waitcnt vmcnt(1)
mid_64:
    v_mov_b32 v4, 0xf1800000
    s_cmp_ge_u32 s3, 8
    s_cselect_b32 s32, 0, 0x7f000000
    v_mov_b32 v5, -2.0
    v_add_f32_e64 v4, s32, v4
    v_fma_f32 v128, v96, v5, v4
    v_min_f32_e64 v128, 0, v128
    v_fma_f32 v129, v97, v5, v4
    v_min_f32_e64 v129, 0, v129
    v_fma_f32 v130, v98, v5, v4
    v_min_f32_e64 v130, 0, v130
    v_fma_f32 v131, v99, v5, v4
    v_min_f32_e64 v131, 0, v131
    v_fma_f32 v132, v100, v5, v4
    v_min_f32_e64 v132, 0, v132
    v_fma_f32 v133, v101, v5, v4
    v_min_f32_e64 v133, 0, v133
    v_fma_f32 v134, v102, v5, v4
    v_min_f32_e64 v134, 0, v134
    v_fma_f32 v135, v103, v5, v4
    v_min_f32_e64 v135, 0, v135
    v_fma_f32 v136, v104, v5, v4
    v_min_f32_e64 v136, 0, v136
    v_fma_f32 v137, v105, v5, v4
    v_min_f32_e64 v137, 0, v137
    v_fma_f32 v138, v106, v5, v4
    v_min_f32_e64 v138, 0, v138
    v_fma_f32 v139, v107, v5, v4
    v_min_f32_e64 v139, 0, v139
    v_fma_f32 v140, v108, v5, v4
    v_min_f32_e64 v140, 0, v140
    v_fma_f32 v141, v109, v5, v4
    v_min_f32_e64 v141, 0, v141
    v_fma_f32 v142, v110, v5, v4
    v_min_f32_e64 v142, 0, v142
    v_fma_f32 v143, v111, v5, v4
    v_min_f32 v143, 0, v143
    v_mov_b32 v24, -1
    v_mov_b32 v25, -1
    v_mov_b32 v26, -1
    v_mov_b32 v27, -1
    v_lshlrev_b32_e64 v15, 4, v0
    s_lshl_b32 s59, s2, 13
    s_waitcnt lgkmcnt(0)
    s_barrier
    s_cmp_eq_u32 s41, 0
    s_cbranch_scc1 p2skip_66
    ds_read_b128 v[88:91], v22 offset:0
    ds_read_b128 v[92:95], v22 offset:4096
    s_mov_b64 exec, s[38:39]
    ds_read_b128 v[72:75], v23 offset:0
    ds_read_b128 v[76:79], v23 offset:1024
    s_mov_b64 exec, -1
    s_waitcnt lgkmcnt(3)
    v_mfma_f32_32x32x16_bf16 v[32:47], v[88:91], v[16:19], v[128:143]
    s_waitcnt lgkmcnt(2)
    v_mfma_f32_32x32x16_bf16 v[48:63], v[92:95], v[16:19], 0
    ds_read_b128 v[88:91], v22 offset:8192
    s_nop 8
    v_exp_f32 v32, v32
    v_exp_f32 v33, v33
    v_exp_f32 v34, v34
    v_exp_f32 v35, v35
    v_exp_f32 v36, v36
    v_exp_f32 v37, v37
    v_exp_f32 v38, v38
    v_exp_f32 v39, v39
    s_mov_b64 exec, s[38:39]
    ds_read_b128 v[80:83], v23 offset:4096
    ds_read_b128 v[84:87], v23 offset:5120
    s_mov_b64 exec, -1
    v_cvt_pk_bf16_f32 v64, v32, v33
    v_cvt_pk_bf16_f32 v65, v34, v35
    v_cvt_pk_bf16_f32 v66, v36, v37
    v_cvt_pk_bf16_f32 v67, v38, v39
    v_exp_f32 v40, v40
    v_exp_f32 v41, v41
    v_exp_f32_e64 v42, v42
    s_waitcnt lgkmcnt(3)
    v_mfma_f32_32x32x16_bf16 v[112:127], v[72:75], v[64:67], v[112:127]
    v_exp_f32 v43, v43
    v_exp_f32 v44, v44
    v_exp_f32 v45, v45
    v_exp_f32 v46, v46
    v_exp_f32_e64 v47, v47
    s_cmp_lg_u32 s55, 0
    s_cbranch_scc1 nf_68
    s_add_u32 s33, s59, 6291456
    buffer_store_dwordx4 v[24:27], v15, s[8:11], s33 offen sc1
nf_68:
    s_cmp_ge_u32 s24, 4
    s_cbranch_scc1 npl_69
    buffer_load_dwordx4 v[192:195], v6, s[8:11], s60 offen offset:0 sc1
    buffer_load_dwordx4 v[196:199], v6, s[8:11], s60 offen offset:1024 sc1
    buffer_load_dwordx4 v[200:203], v6, s[8:11], s60 offen offset:2048 sc1
npl_69:
    v_cvt_pk_bf16_f32 v68, v40, v41
    v_cvt_pk_bf16_f32 v69, v42, v43
    v_cvt_pk_bf16_f32 v70, v44, v45
    v_cvt_pk_bf16_f32 v71, v46, v47
    s_cmp_eq_u32 s41, 1
    s_cbranch_scc1 ex0_70
    s_waitcnt lgkmcnt(0)
    v_mfma_f32_32x32x16_bf16 v[32:47], v[88:91], v[16:19], 0
    ds_read_b128 v[92:95], v22 offset:12288
    v_exp_f32 v48, v48
    v_exp_f32 v49, v49
    v_exp_f32 v50, v50
    v_exp_f32 v51, v51
    v_exp_f32 v52, v52
    v_mfma_f32_32x32x16_bf16 v[112:127], v[76:79], v[68:71], v[112:127]
    v_exp_f32 v53, v53
    v_exp_f32 v54, v54
    v_exp_f32 v55, v55
    s_mov_b64 exec, s[38:39]
    ds_read_b128 v[72:75], v23 offset:8192
    ds_read_b128 v[76:79], v23 offset:9216
    s_mov_b64 exec, -1
    v_cvt_pk_bf16_f32 v64, v48, v49
    v_cvt_pk_bf16_f32 v65, v50, v51
    v_cvt_pk_bf16_f32 v66, v52, v53
    v_cvt_pk_bf16_f32 v67, v54, v55
    v_exp_f32 v56, v56
    v_exp_f32 v57, v57
    v_exp_f32 v58, v58
    v_mfma_f32_32x32x16_bf16 v[112:127], v[80:83], v[64:67], v[112:127]
    v_exp_f32 v59, v59
    v_exp_f32 v60, v60
    v_exp_f32 v61, v61
    v_exp_f32 v62, v62
    v_exp_f32_e64 v63, v63
    s_cmp_lg_u32 s55, 0
    s_cbranch_scc1 nf_71
    s_add_u32 s33, s59, 27262976
    buffer_store_dwordx4 v[24:27], v15, s[8:11], s33 offen sc1
nf_71:
    s_cmp_ge_u32 s24, 4
    s_cbranch_scc1 npl_72
    buffer_load_dwordx4 v[204:207], v6, s[8:11], s60 offen offset:3072 sc1
    buffer_load_dwordx4 v[208:211], v12, s[8:11], s60 offen offset:0 sc1
    buffer_load_dwordx4 v[212:215], v12, s[8:11], s60 offen offset:1024 sc1
npl_72:
    v_cvt_pk_bf16_f32 v68, v56, v57
    v_cvt_pk_bf16_f32 v69, v58, v59
    v_cvt_pk_bf16_f32 v70, v60, v61
    v_cvt_pk_bf16_f32 v71, v62, v63
    s_cmp_eq_u32 s41, 2
    s_cbranch_scc1 ex1_73
    s_waitcnt lgkmcnt(0)
    v_mfma_f32_32x32x16_bf16 v[48:63], v[92:95], v[16:19], 0
    ds_read_b128 v[88:91], v22 offset:16384
    v_exp_f32 v32, v32
    v_exp_f32 v33, v33
    v_exp_f32 v34, v34
    v_exp_f32 v35, v35
    v_exp_f32 v36, v36
    v_mfma_f32_32x32x16_bf16 v[112:127], v[84:87], v[68:71], v[112:127]
    v_exp_f32 v37, v37
    v_exp_f32 v38, v38
    v_exp_f32 v39, v39
    s_mov_b64 exec, s[38:39]
    ds_read_b128 v[80:83], v23 offset:12288
    ds_read_b128 v[84:87], v23 offset:13312
    s_mov_b64 exec, -1
    v_cvt_pk_bf16_f32 v64, v32, v33
    v_cvt_pk_bf16_f32 v65, v34, v35
    v_cvt_pk_bf16_f32 v66, v36, v37
    v_cvt_pk_bf16_f32 v67, v38, v39
    v_exp_f32 v40, v40
    v_exp_f32 v41, v41
    v_exp_f32 v42, v42
    v_mfma_f32_32x32x16_bf16 v[112:127], v[72:75], v[64:67], v[112:127]
    v_exp_f32 v43, v43
    v_exp_f32 v44, v44
    v_exp_f32 v45, v45
    v_exp_f32 v46, v46
    v_exp_f32_e64 v47, v47
    s_cmp_ge_u32 s24, 4
    s_cbranch_scc1 npl_74
    buffer_load_dwordx4 v[216:219], v12, s[8:11], s60 offen offset:2048 sc1
    buffer_load_dwordx4 v[220:223], v12, s[8:11], s60 offen offset:3072 sc1
    s_add_u32 s60, s60, 8192
    buffer_load_dwordx4 v[224:227], v6, s[8:11], s60 offen offset:0 sc1
npl_74:
    v_cvt_pk_bf16_f32 v68, v40, v41
    v_cvt_pk_bf16_f32 v69, v42, v43
    v_cvt_pk_bf16_f32 v70, v44, v45
    v_cvt_pk_bf16_f32 v71, v46, v47
    s_cmp_eq_u32 s41, 3
    s_cbranch_scc1 ex2_75
    s_waitcnt lgkmcnt(0)
    v_mfma_f32_32x32x16_bf16 v[32:47], v[88:91], v[16:19], 0
    ds_read_b128 v[92:95], v22 offset:20480
    v_exp_f32 v48, v48
    v_exp_f32 v49, v49
    v_exp_f32 v50, v50
    v_exp_f32 v51, v51
    v_exp_f32 v52, v52
    v_mfma_f32_32x32x16_bf16 v[112:127], v[76:79], v[68:71], v[112:127]
    v_exp_f32 v53, v53
    v_exp_f32 v54, v54
    v_exp_f32 v55, v55
    s_mov_b64 exec, s[38:39]
    ds_read_b128 v[72:75], v23 offset:16384
    ds_read_b128 v[76:79], v23 offset:17408
    s_mov_b64 exec, -1
    v_cvt_pk_bf16_f32 v64, v48, v49
    v_cvt_pk_bf16_f32 v65, v50, v51
    v_cvt_pk_bf16_f32 v66, v52, v53
    v_cvt_pk_bf16_f32 v67, v54, v55
    v_exp_f32 v56, v56
    v_exp_f32 v57, v57
    v_exp_f32 v58, v58
    v_mfma_f32_32x32x16_bf16 v[112:127], v[80:83], v[64:67], v[112:127]
    v_exp_f32 v59, v59
    v_exp_f32 v60, v60
    v_exp_f32 v61, v61
    v_exp_f32 v62, v62
    v_exp_f32_e64 v63, v63
    s_cmp_ge_u32 s24, 4
    s_cbranch_scc1 npl_76
    buffer_load_dwordx4 v[228:231], v6, s[8:11], s60 offen offset:1024 sc1
    buffer_load_dwordx4 v[232:235], v6, s[8:11], s60 offen offset:2048 sc1
    buffer_load_dwordx4 v[236:239], v6, s[8:11], s60 offen offset:3072 sc1
npl_76:
    v_cvt_pk_bf16_f32 v68, v56, v57
    v_cvt_pk_bf16_f32 v69, v58, v59
    v_cvt_pk_bf16_f32 v70, v60, v61
    v_cvt_pk_bf16_f32 v71, v62, v63
    s_cmp_eq_u32 s41, 4
    s_cbranch_scc1 ex3_77
    s_waitcnt lgkmcnt(0)
    v_mfma_f32_32x32x16_bf16 v[48:63], v[92:95], v[16:19], 0
    ds_read_b128 v[88:91], v22 offset:24576
    v_exp_f32 v32, v32
    v_exp_f32 v33, v33
    v_exp_f32 v34, v34
    v_exp_f32 v35, v35
    v_exp_f32 v36, v36
    v_mfma_f32_32x32x16_bf16 v[112:127], v[84:87], v[68:71], v[112:127]
    v_exp_f32 v37, v37
    v_exp_f32 v38, v38
    v_exp_f32 v39, v39
    s_mov_b64 exec, s[38:39]
    ds_read_b128 v[80:83], v23 offset:20480
    ds_read_b128 v[84:87], v23 offset:21504
    s_mov_b64 exec, -1
    v_cvt_pk_bf16_f32 v64, v32, v33
    v_cvt_pk_bf16_f32 v65, v34, v35
    v_cvt_pk_bf16_f32 v66, v36, v37
    v_cvt_pk_bf16_f32 v67, v38, v39
    v_exp_f32 v40, v40
    v_exp_f32 v41, v41
    v_exp_f32 v42, v42
    v_mfma_f32_32x32x16_bf16 v[112:127], v[72:75], v[64:67], v[112:127]
    v_exp_f32 v43, v43
    v_exp_f32 v44, v44
    v_exp_f32 v45, v45
    v_exp_f32 v46, v46
    v_exp_f32_e64 v47, v47
    s_cmp_ge_u32 s24, 4
    s_cbranch_scc1 npl_78
    buffer_load_dwordx4 v[240:243], v12, s[8:11], s60 offen offset:0 sc1
    buffer_load_dwordx4 v[244:247], v12, s[8:11], s60 offen offset:1024 sc1
npl_78:
    v_cvt_pk_bf16_f32 v68, v40, v41
    v_cvt_pk_bf16_f32 v69, v42, v43
    v_cvt_pk_bf16_f32 v70, v44, v45
    v_cvt_pk_bf16_f32 v71, v46, v47
    s_cmp_eq_u32 s41, 5
    s_cbranch_scc1 ex4_79
    s_waitcnt lgkmcnt(0)
    v_mfma_f32_32x32x16_bf16 v[32:47], v[88:91], v[16:19], 0
    ds_read_b128 v[92:95], v22 offset:28672
    v_exp_f32 v48, v48
    v_exp_f32 v49, v49
    v_exp_f32 v50, v50
    v_exp_f32 v51, v51
    v_exp_f32 v52, v52
    v_mfma_f32_32x32x16_bf16 v[112:127], v[76:79], v[68:71], v[112:127]
    v_exp_f32 v53, v53
    v_exp_f32 v54, v54
    v_exp_f32 v55, v55
    s_mov_b64 exec, s[38:39]
    ds_read_b128 v[72:75], v23 offset:24576
    ds_read_b128 v[76:79], v23 offset:25600
    s_mov_b64 exec, -1
    v_cvt_pk_bf16_f32 v64, v48, v49
    v_cvt_pk_bf16_f32 v65, v50, v51
    v_cvt_pk_bf16_f32 v66, v52, v53
    v_cvt_pk_bf16_f32 v67, v54, v55
    v_exp_f32 v56, v56
    v_exp_f32 v57, v57
    v_exp_f32 v58, v58
    v_mfma_f32_32x32x16_bf16 v[112:127], v[80:83], v[64:67], v[112:127]
    v_exp_f32 v59, v59
    v_exp_f32 v60, v60
    v_exp_f32 v61, v61
    v_exp_f32 v62, v62
    v_exp_f32_e64 v63, v63
    s_cmp_ge_u32 s24, 4
    s_cbranch_scc1 npl_80
    buffer_load_dwordx4 v[248:251], v12, s[8:11], s60 offen offset:2048 sc1
    buffer_load_dwordx4 v[252:255], v12, s[8:11], s60 offen offset:3072 sc1
npl_80:
    v_cvt_pk_bf16_f32 v68, v56, v57
    v_cvt_pk_bf16_f32 v69, v58, v59
    v_cvt_pk_bf16_f32 v70, v60, v61
    v_cvt_pk_bf16_f32 v71, v62, v63
    s_cmp_eq_u32 s41, 6
    s_cbranch_scc1 ex5_81
    s_waitcnt lgkmcnt(0)
    v_mfma_f32_32x32x16_bf16 v[48:63], v[92:95], v[16:19], 0
    v_exp_f32 v32, v32
    v_exp_f32 v33, v33
    v_exp_f32 v34, v34
    v_exp_f32 v35, v35
    v_exp_f32 v36, v36
    v_mfma_f32_32x32x16_bf16 v[112:127], v[84:87], v[68:71], v[112:127]
    v_exp_f32 v37, v37
    v_exp_f32 v38, v38
    v_exp_f32 v39, v39
    s_mov_b64 exec, s[38:39]
    ds_read_b128 v[80:83], v23 offset:28672
    ds_read_b128 v[84:87], v23 offset:29696
    s_mov_b64 exec, -1
    v_cvt_pk_bf16_f32 v64, v32, v33
    v_cvt_pk_bf16_f32 v65, v34, v35
    v_cvt_pk_bf16_f32 v66, v36, v37
    v_cvt_pk_bf16_f32 v67, v38, v39
    v_exp_f32 v40, v40
    v_exp_f32 v41, v41
    v_exp_f32 v42, v42
    v_mfma_f32_32x32x16_bf16 v[112:127], v[72:75], v[64:67], v[112:127]
    v_exp_f32 v43, v43
    v_exp_f32 v44, v44
    v_exp_f32 v45, v45
    v_exp_f32 v46, v46
    v_exp_f32_e64 v47, v47
    v_cvt_pk_bf16_f32 v68, v40, v41
    v_cvt_pk_bf16_f32 v69, v42, v43
    v_cvt_pk_bf16_f32 v70, v44, v45
    v_cvt_pk_bf16_f32 v71, v46, v47
    s_cmp_eq_u32 s41, 7
    s_cbranch_scc1 ex6_82
    v_exp_f32 v48, v48
    v_exp_f32 v49, v49
    v_exp_f32 v50, v50
    v_exp_f32 v51, v51
    v_exp_f32_e64 v52, v52
    v_mfma_f32_32x32x16_bf16 v[112:127], v[76:79], v[68:71], v[112:127]
    v_exp_f32 v53, v53
    v_exp_f32 v54, v54
    v_exp_f32_e64 v55, v55
    v_cvt_pk_bf16_f32 v64, v48, v49
    v_cvt_pk_bf16_f32 v65, v50, v51
    v_cvt_pk_bf16_f32 v66, v52, v53
    v_cvt_pk_bf16_f32 v67, v54, v55
    v_exp_f32 v56, v56
    v_exp_f32 v57, v57
    v_exp_f32 v58, v58
    s_waitcnt lgkmcnt(0)
    v_mfma_f32_32x32x16_bf16 v[112:127], v[80:83], v[64:67], v[112:127]
    v_exp_f32 v59, v59
    v_exp_f32 v60, v60
    v_exp_f32 v61, v61
    v_exp_f32 v62, v62
    v_exp_f32_e64 v63, v63
    v_cvt_pk_bf16_f32 v68, v56, v57
    v_cvt_pk_bf16_f32 v69, v58, v59
    v_cvt_pk_bf16_f32 v70, v60, v61
    v_cvt_pk_bf16_f32 v71, v62, v63
    s_nop 1
    v_mfma_f32_32x32x16_bf16 v[112:127], v[84:87], v[68:71], v[112:127]
adone_67:
    s_lshl_b32 s32, s3, 5
    s_lshl_b32 s33, s29, 1
    s_add_u32 s32, s32, s33
    s_add_u32 s32, s32, s26
    s_lshl_b32 s32, s32, 10
    s_add_u32 s32, s32, s54
    s_setprio 0
    s_nop 4
    v_rcp_f32 v10, v120
    v_mov_b32 v4, 0x2b800000
    v_mov_b32 v5, 0x53800000
    v_med3_f32 v4, v120, v4, v5
    v_cmp_neq_f32 s[34:35], v4, v120
    v_mov_b32_e64 v11, v10
    v_pk_mul_f32 v[112:113], v[112:113], v[10:11]
    v_pk_mul_f32 v[114:115], v[114:115], v[10:11]
    v_pk_mul_f32 v[116:117], v[116:117], v[10:11]
    v_pk_mul_f32 v[118:119], v[118:119], v[10:11]
    v_add_f32 v4, |v112|, |v113|
    v_add_f32 v5, |v114|, |v115|
    v_add_f32 v4, |v116|, v4
    v_add_f32 v5, |v117|, v5
    v_add_f32 v4, |v118|, v4
    v_add_f32 v5, |v119|, v5
    v_add_f32_e64 v4, v4, v5
    v_cmp_class_f32 vcc, v4, s49
    s_nop 0
    s_or_b64 vcc, vcc, s[34:35]
    s_cbranch_vccnz fallback_92
afin_93:
    v_cvt_pk_bf16_f32 v112, v112, v113
    v_cvt_pk_bf16_f32 v113, v114, v115
    v_cvt_pk_bf16_f32 v114, v116, v117
    v_cvt_pk_bf16_f32 v115, v118, v119
    s_waitcnt vmcnt(16)
    buffer_store_dwordx4 v[112:115], v6, s[8:11], s32 offen sc1
    s_waitcnt lgkmcnt(0)
    s_barrier
    s_lshl_b32 s33, s56, 15
    s_lshl_b32 s34, s24, 12
    s_add_u32 s33, s33, s34
    s_add_u32 s33, s33, s54
    s_add_u32 s34, s34, 131072
    v_add_u32 v5, s34, v6
    v_lshlrev_b32 v12, 9, v14
    v_lshl_or_b32 v12, v13, 4, v12
    v_add_u32 v12, 131072, v12
    s_cmp_lg_u32 s55, 0
    s_cbranch_scc1 p2_94
    s_sub_u32 s39, s61, 6144
    v_lshlrev_b32_e64 v7, 5, v13
    v_lshl_or_b32 v7, v14, 3, v7
    v_add_u32_e64 v7, s39, v7
    v_bfe_u32 v8, v1, 2, 2
    v_lshl_add_u32 v8, v14, 3, v8
    v_lshlrev_b32 v8, 5, v8
    v_and_b32 v4, 3, v1
    v_lshl_or_b32 v8, v4, 3, v8
    v_add_u32 v8, s39, v8
    v_lshlrev_b32_e64 v9, 5, v2
    s_lshl_b32 s32, s24, 2
    s_add_u32 s32, s32, 101376
    v_add_u32 v9, s32, v9
    s_or_b32 s32, s57, s24
    v_or_b32 v4, s32, v14
    v_min_u32 v4, 1, v4
    v_cvt_f32_u32 v10, v4
    v_lshlrev_b32 v11, 6, v13
    v_lshl_or_b32 v11, v14, 4, v11
    v_bfe_u32 v4, v1, 2, 2
    v_lshl_add_u32 v4, v14, 2, v4
    v_lshlrev_b32 v4, 6, v4
    v_and_b32 v15, 3, v1
    v_lshl_or_b32 v4, v15, 3, v4
    v_add_u32 v4, s61, v4
    s_waitcnt vmcnt(3)
    ds_read_b64_tr_b16 v[48:49], v4
    ds_read_b64_tr_b16 v[50:51], v4 offset:32
    s_lshl_b32 s35, s57, 3
    s_add_u32 s35, s35, s24
    s_lshl_b32 s35, s35, 10
    s_lshl_b32 s32, s56, 15
    s_add_u32 s35, s35, s32
    s_add_u32 s35, s35, 4194304
    s_waitcnt lgkmcnt(0)
    v_lshlrev_b32_e64 v80, 16, v48
    v_and_b32 v81, 0xffff0000, v48
    v_lshlrev_b32_e64 v82, 16, v49
    v_and_b32 v83, 0xffff0000, v49
    v_lshlrev_b32_e64 v84, 16, v50
    v_and_b32 v85, 0xffff0000, v50
    v_lshlrev_b32_e64 v86, 16, v51
    v_and_b32 v87, 0xffff0000, v51
    s_mov_b32 s62, 1
    v_and_b32 v15, 3, v1
    v_lshlrev_b32_e64 v15, 10, v15
opoll_96:
    buffer_load_dword v4, v15, s[8:11], s33 offen offset:1020 sc1
    s_cmp_ge_u32 s24, 4
    s_cbranch_scc1 ntw_98
    s_cmp_eq_u32 s62, 2
    s_cbranch_scc1 ntw_98
    s_mov_b32 s62, 2
    s_call_b64 s[6:7], GEN_TW
ntw_98:
    s_waitcnt vmcnt(0)
    v_cmp_eq_u32 vcc, -1, v4
    s_nop 0
    s_cbranch_vccz px_99
    s_sub_u32 s58, s58, 1
    s_cbranch_scc0 opoll_96
    s_mov_b32 s58, 0
px_99:
oheavy_97:
    buffer_load_dwordx4 v[32:35], v6, s[8:11], s33 offen offset:0 sc1
    buffer_load_dwordx4 v[36:39], v6, s[8:11], s33 offen offset:1024 sc1
    buffer_load_dwordx4 v[40:43], v6, s[8:11], s33 offen offset:2048 sc1
    buffer_load_dwordx4 v[44:47], v6, s[8:11], s33 offen offset:3072 sc1
    s_cmp_ge_u32 s24, 4
    s_cbranch_scc1 ntw_100
    s_cmp_eq_u32 s62, 2
    s_cbranch_scc1 ntw_100
    s_mov_b32 s62, 2
    s_call_b64 s[6:7], GEN_TW
ntw_100:
    s_waitcnt vmcnt(0)
    v_max_u32_e64 v4, v32, v33
    v_max3_u32 v4, v34, v35, v4
    v_max3_u32 v4, v36, v37, v4
    v_max3_u32 v4, v38, v39, v4
    v_max3_u32 v4, v40, v41, v4
    v_max3_u32 v4, v42, v43, v4
    v_max3_u32 v4, v44, v45, v4
    v_max3_u32 v4, v46, v47, v4
    v_cmp_eq_u32 vcc, -1, v4
    s_nop 0
    s_cbranch_vccz px_101
    s_sub_u32 s58, s58, 1
    s_cbranch_scc0 opoll_96
    s_mov_b32 s58, 0
px_101:
    ds_write_b128 v5, v[32:35] offset:0
    ds_write_b128 v5, v[36:39] offset:1024
    ds_write_b128 v5, v[40:43] offset:2048
    ds_write_b128 v5, v[44:47] offset:3072
    s_waitcnt lgkmcnt(0)
    s_cmp_ge_u32 s24, 4
    s_cbranch_scc1 nocc_102
    s_lshl_b32 s30, s2, 13
    s_lshl_b32 s31, s24, 11
    s_add_u32 s30, s30, s31
    s_add_u32 s30, s30, 12582912
    buffer_load_dwordx4 v[88:91], v6, s[8:11], s30 offen sc1
    buffer_load_dwordx4 v[92:95], v6, s[8:11], s30 offen offset:1024 sc1
    s_branch nocc_102_j
nocc_102:
    s_mov_b32 s5, s33
    s_mov_b32 s4, s34
    v_and_b32 v4, 255, v0
    v_lshlrev_b32 v4, 6, v4
    s_lshr_b32 s34, s2, 3
    s_lshl_b32 s34, s34, 14
    s_add_u32 s33, s34, 12058624
    buffer_load_dword v16, v4, s[8:11], s33 offen sc1
    s_mov_b32 s33, s5
    s_mov_b32 s34, s4
nocc_102_j:
    s_barrier
    s_nop 0
    ds_read_b128 v[48:51], v12 offset:0
    ds_read_b128 v[52:55], v12 offset:256
    ds_read_b128 v[56:59], v12 offset:2048
    ds_read_b128 v[60:63], v12 offset:2304
    ds_read_b128 v[64:67], v12 offset:4096
    ds_read_b128 v[68:71], v12 offset:4352
    ds_read_b128 v[72:75], v12 offset:6144
    s_waitcnt lgkmcnt(6)
    v_mfma_f32_16x16x32_bf16 v[80:83], v[192:195], v[48:51], v[80:83]
    ds_read_b128 v[76:79], v12 offset:6400
    s_waitcnt lgkmcnt(6)
    v_mfma_f32_16x16x32_bf16 v[84:87], v[192:195], v[52:55], v[84:87]
    ds_read_b128 v[48:51], v12 offset:8192
    s_waitcnt lgkmcnt(6)
    v_mfma_f32_16x16x32_bf16 v[80:83], v[196:199], v[56:59], v[80:83]
    ds_read_b128 v[52:55], v12 offset:8448
    s_waitcnt lgkmcnt(6)
    v_mfma_f32_16x16x32_bf16 v[84:87], v[196:199], v[60:63], v[84:87]
    ds_read_b128 v[56:59], v12 offset:10240
    s_waitcnt lgkmcnt(6)
    v_mfma_f32_16x16x32_bf16 v[80:83], v[200:203], v[64:67], v[80:83]
    ds_read_b128 v[60:63], v12 offset:10496
    s_waitcnt lgkmcnt(6)
    v_mfma_f32_16x16x32_bf16 v[84:87], v[200:203], v[68:71], v[84:87]
    ds_read_b128 v[64:67], v12 offset:12288
    s_waitcnt lgkmcnt(6)
    v_mfma_f32_16x16x32_bf16 v[80:83], v[204:207], v[72:75], v[80:83]
    ds_read_b128 v[68:71], v12 offset:12544
    s_waitcnt lgkmcnt(6)
    v_mfma_f32_16x16x32_bf16 v[84:87], v[204:207], v[76:79], v[84:87]
    ds_read_b128 v[72:75], v12 offset:14336
    s_waitcnt lgkmcnt(6)
    v_mfma_f32_16x16x32_bf16 v[80:83], v[208:211], v[48:51], v[80:83]
    ds_read_b128 v[76:79], v12 offset:14592
    s_waitcnt lgkmcnt(6)
    v_mfma_f32_16x16x32_bf16 v[84:87], v[208:211], v[52:55], v[84:87]
    ds_read_b128 v[48:51], v12 offset:16384
    s_waitcnt lgkmcnt(6)
    v_mfma_f32_16x16x32_bf16 v[80:83], v[212:215], v[56:59], v[80:83]
    ds_read_b128 v[52:55], v12 offset:16640
    s_waitcnt lgkmcnt(6)
    v_mfma_f32_16x16x32_bf16 v[84:87], v[212:215], v[60:63], v[84:87]
    ds_read_b128 v[56:59], v12 offset:18432
    s_waitcnt lgkmcnt(6)
    v_mfma_f32_16x16x32_bf16 v[80:83], v[216:219], v[64:67], v[80:83]
    ds_read_b128 v[60:63], v12 offset:18688
    s_waitcnt lgkmcnt(6)
    v_mfma_f32_16x16x32_bf16 v[84:87], v[216:219], v[68:71], v[84:87]
    ds_read_b128 v[64:67], v12 offset:20480
    s_waitcnt lgkmcnt(6)
    v_mfma_f32_16x16x32_bf16 v[80:83], v[220:223], v[72:75], v[80:83]
    ds_read_b128 v[68:71], v12 offset:20736
    s_waitcnt lgkmcnt(6)
    v_mfma_f32_16x16x32_bf16 v[84:87], v[220:223], v[76:79], v[84:87]
    ds_read_b128 v[72:75], v12 offset:22528
    s_waitcnt lgkmcnt(6)
    v_mfma_f32_16x16x32_bf16 v[80:83], v[224:227], v[48:51], v[80:83]
    ds_read_b128 v[76:79], v12 offset:22784
    s_waitcnt lgkmcnt(6)
    v_mfma_f32_16x16x32_bf16 v[84:87], v[224:227], v[52:55], v[84:87]
    ds_read_b128 v[48:51], v12 offset:24576
    s_waitcnt lgkmcnt(6)
    v_mfma_f32_16x16x32_bf16 v[80:83], v[228:231], v[56:59], v[80:83]
    ds_read_b128 v[52:55], v12 offset:24832
    s_waitcnt lgkmcnt(6)
    v_mfma_f32_16x16x32_bf16 v[84:87], v[228:231], v[60:63], v[84:87]
    ds_read_b128 v[56:59], v12 offset:26624
    s_waitcnt lgkmcnt(6)
    v_mfma_f32_16x16x32_bf16 v[80:83], v[232:235], v[64:67], v[80:83]
    ds_read_b128 v[60:63], v12 offset:26880
    s_waitcnt lgkmcnt(6)
    v_mfma_f32_16x16x32_bf16 v[84:87], v[232:235], v[68:71], v[84:87]
    ds_read_b128 v[64:67], v12 offset:28672
    s_waitcnt lgkmcnt(6)
    v_mfma_f32_16x16x32_bf16 v[80:83], v[236:239], v[72:75], v[80:83]
    ds_read_b128 v[68:71], v12 offset:28928
    s_waitcnt lgkmcnt(6)
    v_mfma_f32_16x16x32_bf16 v[84:87], v[236:239], v[76:79], v[84:87]
    ds_read_b128 v[72:75], v12 offset:30720
    s_waitcnt lgkmcnt(6)
    v_mfma_f32_16x16x32_bf16 v[80:83], v[240:243], v[48:51], v[80:83]
    ds_read_b128 v[76:79], v12 offset:30976
    s_waitcnt lgkmcnt(6)
    v_mfma_f32_16x16x32_bf16 v[84:87], v[240:243], v[52:55], v[84:87]
    s_waitcnt lgkmcnt(5)
    v_mfma_f32_16x16x32_bf16 v[80:83], v[244:247], v[56:59], v[80:83]
    s_waitcnt lgkmcnt(4)
    v_mfma_f32_16x16x32_bf16 v[84:87], v[244:247], v[60:63], v[84:87]
    s_waitcnt lgkmcnt(3)
    v_mfma_f32_16x16x32_bf16 v[80:83], v[248:251], v[64:67], v[80:83]
    s_waitcnt lgkmcnt(2)
    v_mfma_f32_16x16x32_bf16 v[84:87], v[248:251], v[68:71], v[84:87]
    s_waitcnt lgkmcnt(1)
    v_mfma_f32_16x16x32_bf16 v[80:83], v[252:255], v[72:75], v[80:83]
    s_waitcnt lgkmcnt(0)
    v_mfma_f32_16x16x32_bf16 v[84:87], v[252:255], v[76:79], v[84:87]
    s_nop 5
    s_nop 0
    v_cvt_pk_bf16_f32 v32, v80, v81
    v_cvt_pk_bf16_f32 v33, v82, v83
    ds_write_b64 v7, v[32:33] offset:0
    v_cvt_pk_bf16_f32 v34, v84, v85
    v_cvt_pk_bf16_f32 v35, v86, v87
    ds_write_b64 v7, v[34:35] offset:512
    v_mul_f32 v36, v80, v10
    v_mul_f32 v36, v36, v80
    v_fmac_f32 v36, v81, v81
    v_fmac_f32 v36, v82, v82
    v_fmac_f32 v36, v83, v83
    v_mul_f32 v37, v84, v10
    v_mul_f32_e64 v37, v37, v84
    v_fmac_f32 v37, v85, v85
    v_fmac_f32 v37, v86, v86
    v_fmac_f32 v37, v87, v87
    s_waitcnt lgkmcnt(0)
    ds_read_b64_tr_b16 v[32:33], v8
    ds_read_b64_tr_b16 v[34:35], v8 offset:128
    v_permlane16_swap_b32 v36, v37
    v_add_f32 v36, v36, v37
    v_mov_b32 v37, v36
    s_nop 1
    v_permlane32_swap_b32 v36, v37
    v_add_f32 v36, v36, v37
    ds_write_b32 v9, v36
    s_waitcnt lgkmcnt(1)
    buffer_store_dwordx4 v[32:35], v11, s[8:11], s35 offen sc1
    s_waitcnt lgkmcnt(0)
    s_barrier
    s_cmp_lg_u32 s24, 0
    s_cbranch_scc1 sk_103
    v_lshlrev_b32 v5, 5, v2
    v_lshl_or_b32 v5, v3, 4, v5
    v_add_u32 v5, 101376, v5
    ds_read_b128 v[40:43], v5
    v_lshlrev_b32 v4, 2, v2
    s_lshl_b32 s32, s57, 13
    s_lshl_b32 s33, s56, 7
    s_add_u32 s32, s32, s33
    s_add_u32 s32, s32, 8454144
    s_waitcnt lgkmcnt(0)
    v_add_f32 v40, v40, v41
    v_add_f32 v42, v42, v43
    v_add_f32 v40, v40, v42
    v_mov_b32 v5, v40
    s_nop 1
    v_permlane32_swap_b32 v40, v5
    v_add_f32 v5, v40, v5
    buffer_store_dword v5, v4, s[8:11], s32 offen sc1
sk_103:
    s_branch pc_95
p2_94:
    v_lshlrev_b32 v7, 10, v13
    v_lshl_or_b32 v7, v14, 3, v7
    v_add_u32 v8, 16384, v7
    s_lshl_b32 s35, s56, 15
    s_lshl_b32 s32, s57, 8
    s_add_u32 s35, s35, s32
    s_lshl_b32 s32, s24, 5
    s_add_u32 s35, s35, s32
    s_lshl_b32 s32, s57, 3
    s_add_u32 s32, s32, s24
    s_lshl_b32 s32, s32, 10
    s_lshl_b32 s30, s56, 15
    s_add_u32 s32, s32, s30
    s_add_u32 s32, s32, 29360128
    v_lshlrev_b32_e64 v9, 5, v13
    v_lshl_or_b32 v9, v14, 3, v9
    v_and_b32 v15, 3, v1
    v_lshlrev_b32 v15, 10, v15
opoll_104:
    buffer_load_dword v4, v15, s[8:11], s33 offen offset:1020 sc1
    s_waitcnt vmcnt(0)
    v_cmp_eq_u32 vcc, -1, v4
    s_nop 0
    s_cbranch_vccz px_106
    s_sub_u32 s58, s58, 1
    s_cbranch_scc0 opoll_104
    s_mov_b32 s58, 0
px_106:
oheavy_105:
    buffer_load_dwordx4 v[32:35], v6, s[8:11], s33 offen offset:0 sc1
    buffer_load_dwordx4 v[36:39], v6, s[8:11], s33 offen offset:1024 sc1
    buffer_load_dwordx4 v[40:43], v6, s[8:11], s33 offen offset:2048 sc1
    buffer_load_dwordx4 v[44:47], v6, s[8:11], s33 offen offset:3072 sc1
    s_waitcnt vmcnt(0)
    v_max_u32_e64 v4, v32, v33
    v_max3_u32 v4, v34, v35, v4
    v_max3_u32 v4, v36, v37, v4
    v_max3_u32 v4, v38, v39, v4
    v_max3_u32 v4, v40, v41, v4
    v_max3_u32 v4, v42, v43, v4
    v_max3_u32 v4, v44, v45, v4
    v_max3_u32 v4, v46, v47, v4
    v_cmp_eq_u32 vcc, -1, v4
    s_nop 0
    s_cbranch_vccz px_107
    s_sub_u32 s58, s58, 1
    s_cbranch_scc0 opoll_104
    s_mov_b32 s58, 0
px_107:
    ds_write_b128 v5, v[32:35] offset:0
    ds_write_b128 v5, v[36:39] offset:1024
    ds_write_b128 v5, v[40:43] offset:2048
    ds_write_b128 v5, v[44:47] offset:3072
    s_waitcnt lgkmcnt(0)
    s_barrier
    buffer_load_dwordx2 v[32:33], v9, s[8:11], s32 offen sc1
    buffer_load_dwordx2 v[34:35], v9, s[8:11], s32 offen offset:512 sc1
    ds_read_b128 v[48:51], v12 offset:0
    ds_read_b128 v[52:55], v12 offset:256
    ds_read_b128 v[56:59], v12 offset:2048
    ds_read_b128 v[60:63], v12 offset:2304
    ds_read_b128 v[64:67], v12 offset:4096
    ds_read_b128 v[68:71], v12 offset:4352
    ds_read_b128 v[72:75], v12 offset:6144
    s_waitcnt lgkmcnt(6)
    v_mfma_f32_16x16x32_bf16 v[80:83], v[192:195], v[48:51], 0
    ds_read_b128 v[76:79], v12 offset:6400
    s_waitcnt lgkmcnt(6)
    v_mfma_f32_16x16x32_bf16 v[84:87], v[192:195], v[52:55], 0
    ds_read_b128 v[48:51], v12 offset:8192
    s_waitcnt lgkmcnt(6)
    v_mfma_f32_16x16x32_bf16 v[80:83], v[196:199], v[56:59], v[80:83]
    ds_read_b128 v[52:55], v12 offset:8448
    s_waitcnt lgkmcnt(6)
    v_mfma_f32_16x16x32_bf16 v[84:87], v[196:199], v[60:63], v[84:87]
    ds_read_b128 v[56:59], v12 offset:10240
    s_waitcnt lgkmcnt(6)
    v_mfma_f32_16x16x32_bf16 v[80:83], v[200:203], v[64:67], v[80:83]
    ds_read_b128 v[60:63], v12 offset:10496
    s_waitcnt lgkmcnt(6)
    v_mfma_f32_16x16x32_bf16 v[84:87], v[200:203], v[68:71], v[84:87]
    ds_read_b128 v[64:67], v12 offset:12288
    s_waitcnt lgkmcnt(6)
    v_mfma_f32_16x16x32_bf16 v[80:83], v[204:207], v[72:75], v[80:83]
    ds_read_b128 v[68:71], v12 offset:12544
    s_waitcnt lgkmcnt(6)
    v_mfma_f32_16x16x32_bf16 v[84:87], v[204:207], v[76:79], v[84:87]
    ds_read_b128 v[72:75], v12 offset:14336
    s_waitcnt lgkmcnt(6)
    v_mfma_f32_16x16x32_bf16 v[80:83], v[208:211], v[48:51], v[80:83]
    ds_read_b128 v[76:79], v12 offset:14592
    s_waitcnt lgkmcnt(6)
    v_mfma_f32_16x16x32_bf16 v[84:87], v[208:211], v[52:55], v[84:87]
    ds_read_b128 v[48:51], v12 offset:16384
    s_waitcnt lgkmcnt(6)
    v_mfma_f32_16x16x32_bf16 v[80:83], v[212:215], v[56:59], v[80:83]
    ds_read_b128 v[52:55], v12 offset:16640
    s_waitcnt lgkmcnt(6)
    v_mfma_f32_16x16x32_bf16 v[84:87], v[212:215], v[60:63], v[84:87]
    ds_read_b128 v[56:59], v12 offset:18432
    s_waitcnt lgkmcnt(6)
    v_mfma_f32_16x16x32_bf16 v[80:83], v[216:219], v[64:67], v[80:83]
    ds_read_b128 v[60:63], v12 offset:18688
    s_waitcnt lgkmcnt(6)
    v_mfma_f32_16x16x32_bf16 v[84:87], v[216:219], v[68:71], v[84:87]
    ds_read_b128 v[64:67], v12 offset:20480
    s_waitcnt lgkmcnt(6)
    v_mfma_f32_16x16x32_bf16 v[80:83], v[220:223], v[72:75], v[80:83]
    ds_read_b128 v[68:71], v12 offset:20736
    s_waitcnt lgkmcnt(6)
    v_mfma_f32_16x16x32_bf16 v[84:87], v[220:223], v[76:79], v[84:87]
    ds_read_b128 v[72:75], v12 offset:22528
    s_waitcnt lgkmcnt(6)
    v_mfma_f32_16x16x32_bf16 v[80:83], v[224:227], v[48:51], v[80:83]
    ds_read_b128 v[76:79], v12 offset:22784
    s_waitcnt lgkmcnt(6)
    v_mfma_f32_16x16x32_bf16 v[84:87], v[224:227], v[52:55], v[84:87]
    ds_read_b128 v[48:51], v12 offset:24576
    s_waitcnt lgkmcnt(6)
    v_mfma_f32_16x16x32_bf16 v[80:83], v[228:231], v[56:59], v[80:83]
    ds_read_b128 v[52:55], v12 offset:24832
    s_waitcnt lgkmcnt(6)
    v_mfma_f32_16x16x32_bf16 v[84:87], v[228:231], v[60:63], v[84:87]
    ds_read_b128 v[56:59], v12 offset:26624
    s_waitcnt lgkmcnt(6)
    v_mfma_f32_16x16x32_bf16 v[80:83], v[232:235], v[64:67], v[80:83]
    ds_read_b128 v[60:63], v12 offset:26880
    s_waitcnt lgkmcnt(6)
    v_mfma_f32_16x16x32_bf16 v[84:87], v[232:235], v[68:71], v[84:87]
    ds_read_b128 v[64:67], v12 offset:28672
    s_waitcnt lgkmcnt(6)
    v_mfma_f32_16x16x32_bf16 v[80:83], v[236:239], v[72:75], v[80:83]
    ds_read_b128 v[68:71], v12 offset:28928
    s_waitcnt lgkmcnt(6)
    v_mfma_f32_16x16x32_bf16 v[84:87], v[236:239], v[76:79], v[84:87]
    ds_read_b128 v[72:75], v12 offset:30720
    s_waitcnt lgkmcnt(6)
    v_mfma_f32_16x16x32_bf16 v[80:83], v[240:243], v[48:51], v[80:83]
    ds_read_b128 v[76:79], v12 offset:30976
    s_waitcnt lgkmcnt(6)
    v_mfma_f32_16x16x32_bf16 v[84:87], v[240:243], v[52:55], v[84:87]
    s_waitcnt lgkmcnt(5)
    v_mfma_f32_16x16x32_bf16 v[80:83], v[244:247], v[56:59], v[80:83]
    s_waitcnt lgkmcnt(4)
    v_mfma_f32_16x16x32_bf16 v[84:87], v[244:247], v[60:63], v[84:87]
    s_waitcnt lgkmcnt(3)
    v_mfma_f32_16x16x32_bf16 v[80:83], v[248:251], v[64:67], v[80:83]
    s_waitcnt lgkmcnt(2)
    v_mfma_f32_16x16x32_bf16 v[84:87], v[248:251], v[68:71], v[84:87]
    s_waitcnt lgkmcnt(1)
    v_mfma_f32_16x16x32_bf16 v[80:83], v[252:255], v[72:75], v[80:83]
    s_waitcnt lgkmcnt(0)
    v_mfma_f32_16x16x32_bf16 v[84:87], v[252:255], v[76:79], v[84:87]
    s_waitcnt vmcnt(0)
    v_lshlrev_b32 v36, 16, v32
    v_and_b32 v37, 0xffff0000, v32
    v_lshlrev_b32_e64 v38, 16, v33
    v_and_b32 v39, 0xffff0000, v33
    v_lshlrev_b32_e64 v40, 16, v34
    v_and_b32 v41, 0xffff0000, v34
    v_lshlrev_b32_e64 v42, 16, v35
    v_and_b32 v43, 0xffff0000, v35
    v_add_f32 v80, v80, v36
    v_add_f32 v81, v81, v37
    v_add_f32 v82, v82, v38
    v_add_f32 v83, v83, v39
    v_add_f32 v84, v84, v40
    v_add_f32 v85, v85, v41
    v_add_f32 v86, v86, v42
    v_add_f32 v87, v87, v43
    v_cvt_pk_bf16_f32 v32, v80, v81
    v_cvt_pk_bf16_f32 v33, v82, v83
    buffer_store_dwordx2 v[32:33], v7, s[20:23], s35 offen
    v_cvt_pk_bf16_f32 v34, v84, v85
    v_cvt_pk_bf16_f32 v35, v86, v87
    buffer_store_dwordx2 v[34:35], v8, s[20:23], s35 offen
    s_branch fin_1
pc_95:
    s_setprio 0
    s_mov_b32 s50, 4194304
    s_mov_b32 s51, 6291456
    s_mov_b32 s52, 8454144
    s_mov_b32 s53, 20971520
    s_mov_b32 s54, 27262976
    s_mov_b32 s55, 1
    s_branch layer_17
GEN_F2:
    s_lshl_b32 s32, s34, 4
    v_add_u32 v4, s32, v13
    v_lshrrev_b32 v5, 1, v4
    v_and_b32 v7, 1, v4
    v_cmp_eq_u32 vcc, 0, v5
    v_lshlrev_b32 v8, 8, v7
    s_nop 0
    v_cndmask_b32 v5, v5, v8, vcc
    v_lshlrev_b32 v7, 7, v7
    v_mov_b32 v8, 64
    v_cndmask_b32 v7, v7, v8, vcc
    v_lshlrev_b32 v8, 3, v14
    v_mad_u32_u24 v7, v5, v8, v7
    v_mov_b32 v10, 0x3b000000
    v_cvt_f32_u32 v7, v7
    v_mul_f32 v7, v7, v10
    v_cvt_f32_u32 v9, v5
    v_mul_f32 v9, v9, v10
    v_mul_f32 v8, 0x42000000, v9
    v_cos_f32_e64 v11, v8
    v_mul_f32 v10, 0x41c80000, v9
    v_add_f32 v11, v11, v11
    v_cos_f32 v32, v7
    v_add_f32 v7, v9, v7
    v_cos_f32 v33, v7
    v_add_f32 v7, v9, v7
    v_cos_f32 v34, v7
    v_add_f32 v7, v9, v7
    v_cos_f32 v35, v7
    v_add_f32 v7, v9, v7
    v_cos_f32 v36, v7
    v_add_f32 v7, v9, v7
    v_cos_f32 v37, v7
    v_add_f32 v7, v9, v7
    v_cos_f32 v38, v7
    v_add_f32 v7, v9, v7
    v_cos_f32 v39, v7
    v_add_f32 v7, v10, v7
    v_cos_f32 v40, v7
    v_add_f32 v7, v9, v7
    v_cos_f32 v41, v7
    v_add_f32 v7, v9, v7
    v_cos_f32 v42, v7
    v_add_f32 v7, v9, v7
    v_cos_f32 v43, v7
    v_add_f32 v7, v9, v7
    v_cos_f32 v44, v7
    v_add_f32 v7, v9, v7
    v_cos_f32 v45, v7
    v_add_f32 v7, v9, v7
    v_cos_f32 v46, v7
    v_add_f32 v7, v9, v7
    v_cos_f32 v47, v7
    v_mov_b32 v8, 0x3d800000
    v_mov_b32_e64 v9, v8
    v_pk_mul_f32 v[32:33], v[32:33], v[8:9]
    v_pk_mul_f32 v[34:35], v[34:35], v[8:9]
    v_pk_mul_f32 v[36:37], v[36:37], v[8:9]
    v_pk_mul_f32 v[38:39], v[38:39], v[8:9]
    v_pk_mul_f32 v[40:41], v[40:41], v[8:9]
    v_pk_mul_f32 v[42:43], v[42:43], v[8:9]
    v_pk_mul_f32 v[44:45], v[44:45], v[8:9]
    v_pk_mul_f32 v[46:47], v[46:47], v[8:9]
    v_and_b32_e64 v8, 1, v5
    v_mul_u32_u24 v8, 0x8000, v8
    v_lshl_or_b32 v8, v8, 16, v8
    v_cvt_pk_bf16_f32 v64, v32, v33
    v_cvt_pk_bf16_f32 v65, v34, v35
    v_cvt_pk_bf16_f32 v66, v36, v37
    v_cvt_pk_bf16_f32 v67, v38, v39
    v_cvt_pk_bf16_f32 v68, v40, v41
    v_cvt_pk_bf16_f32 v69, v42, v43
    v_cvt_pk_bf16_f32 v70, v44, v45
    v_cvt_pk_bf16_f32 v71, v46, v47
    v_fma_f32 v32, v11, v40, -v32
    v_fma_f32 v33, v11, v41, -v33
    v_fma_f32 v34, v11, v42, -v34
    v_fma_f32 v35, v11, v43, -v35
    v_fma_f32 v36, v11, v44, -v36
    v_fma_f32 v37, v11, v45, -v37
    v_fma_f32 v38, v11, v46, -v38
    v_fma_f32 v39, v11, v47, -v39
    v_cvt_pk_bf16_f32 v72, v32, v33
    v_cvt_pk_bf16_f32 v73, v34, v35
    v_cvt_pk_bf16_f32 v74, v36, v37
    v_cvt_pk_bf16_f32 v75, v38, v39
    v_fma_f32 v40, v11, v32, -v40
    v_fma_f32 v41, v11, v33, -v41
    v_fma_f32 v42, v11, v34, -v42
    v_fma_f32 v43, v11, v35, -v43
    v_fma_f32 v44, v11, v36, -v44
    v_fma_f32 v45, v11, v37, -v45
    v_fma_f32 v46, v11, v38, -v46
    v_fma_f32 v47, v11, v39, -v47
    v_cvt_pk_bf16_f32 v76, v40, v41
    v_cvt_pk_bf16_f32 v77, v42, v43
    v_cvt_pk_bf16_f32 v78, v44, v45
    v_cvt_pk_bf16_f32 v79, v46, v47
    v_fma_f32 v32, v11, v40, -v32
    v_fma_f32 v33, v11, v41, -v33
    v_fma_f32 v34, v11, v42, -v34
    v_fma_f32 v35, v11, v43, -v35
    v_fma_f32 v36, v11, v44, -v36
    v_fma_f32 v37, v11, v45, -v37
    v_fma_f32 v38, v11, v46, -v38
    v_fma_f32 v39, v11, v47, -v39
    v_cvt_pk_bf16_f32 v80, v32, v33
    v_cvt_pk_bf16_f32 v81, v34, v35
    v_cvt_pk_bf16_f32 v82, v36, v37
    v_cvt_pk_bf16_f32 v83, v38, v39
    v_fma_f32 v40, v11, v32, -v40
    v_fma_f32 v41, v11, v33, -v41
    v_fma_f32 v42, v11, v34, -v42
    v_fma_f32 v43, v11, v35, -v43
    v_fma_f32 v44, v11, v36, -v44
    v_fma_f32 v45, v11, v37, -v45
    v_fma_f32 v46, v11, v38, -v46
    v_fma_f32 v47, v11, v39, -v47
    v_cvt_pk_bf16_f32 v84, v40, v41
    v_cvt_pk_bf16_f32 v85, v42, v43
    v_cvt_pk_bf16_f32 v86, v44, v45
    v_cvt_pk_bf16_f32 v87, v46, v47
    v_fma_f32 v32, v11, v40, -v32
    v_fma_f32 v33, v11, v41, -v33
    v_fma_f32 v34, v11, v42, -v34
    v_fma_f32 v35, v11, v43, -v35
    v_fma_f32 v36, v11, v44, -v36
    v_fma_f32 v37, v11, v45, -v37
    v_fma_f32 v38, v11, v46, -v38
    v_fma_f32 v39, v11, v47, -v39
    v_cvt_pk_bf16_f32 v88, v32, v33
    v_cvt_pk_bf16_f32 v89, v34, v35
    v_cvt_pk_bf16_f32 v90, v36, v37
    v_cvt_pk_bf16_f32 v91, v38, v39
    v_fma_f32 v40, v11, v32, -v40
    v_fma_f32 v41, v11, v33, -v41
    v_fma_f32 v42, v11, v34, -v42
    v_fma_f32 v43, v11, v35, -v43
    v_fma_f32 v44, v11, v36, -v44
    v_fma_f32 v45, v11, v37, -v45
    v_fma_f32 v46, v11, v38, -v46
    v_fma_f32 v47, v11, v39, -v47
    v_cvt_pk_bf16_f32 v92, v40, v41
    v_cvt_pk_bf16_f32 v93, v42, v43
    v_cvt_pk_bf16_f32 v94, v44, v45
    v_cvt_pk_bf16_f32 v95, v46, v47
    v_xor_b32 v96, v8, v64
    v_xor_b32 v97, v8, v65
    v_xor_b32 v98, v8, v66
    v_xor_b32 v99, v8, v67
    v_xor_b32 v100, v8, v68
    v_xor_b32 v101, v8, v69
    v_xor_b32 v102, v8, v70
    v_xor_b32 v103, v8, v71
    v_xor_b32 v104, v8, v72
    v_xor_b32 v105, v8, v73
    v_xor_b32 v106, v8, v74
    v_xor_b32 v107, v8, v75
    v_xor_b32 v108, v8, v76
    v_xor_b32 v109, v8, v77
    v_xor_b32 v110, v8, v78
    v_xor_b32 v111, v8, v79
    v_xor_b32 v112, v8, v80
    v_xor_b32 v113, v8, v81
    v_xor_b32 v114, v8, v82
    v_xor_b32 v115, v8, v83
    v_xor_b32 v116, v8, v84
    v_xor_b32 v117, v8, v85
    v_xor_b32 v118, v8, v86
    v_xor_b32 v119, v8, v87
    v_xor_b32 v120, v8, v88
    v_xor_b32 v121, v8, v89
    v_xor_b32 v122, v8, v90
    v_xor_b32 v123, v8, v91
    v_xor_b32 v124, v8, v92
    v_xor_b32 v125, v8, v93
    v_xor_b32 v126, v8, v94
    v_xor_b32 v127, v8, v95
    s_lshl_b32 s32, s39, 4
    v_add_u32 v4, s32, v13
    v_lshrrev_b32 v5, 1, v4
    v_and_b32 v7, 1, v4
    v_cmp_eq_u32 vcc, 0, v5
    v_lshlrev_b32 v8, 8, v7
    s_nop 0
    v_cndmask_b32 v5, v5, v8, vcc
    v_lshlrev_b32 v7, 7, v7
    v_mov_b32 v8, 64
    v_cndmask_b32 v7, v7, v8, vcc
    v_lshlrev_b32 v8, 3, v14
    v_mad_u32_u24 v7, v5, v8, v7
    v_mov_b32 v10, 0x3b000000
    v_cvt_f32_u32 v7, v7
    v_mul_f32 v7, v7, v10
    v_cvt_f32_u32 v9, v5
    v_mul_f32 v9, v9, v10
    v_mul_f32 v8, 0x42000000, v9
    v_cos_f32_e64 v11, v8
    v_mul_f32 v10, 0x41c80000, v9
    v_add_f32 v11, v11, v11
    v_cos_f32 v32, v7
    v_add_f32 v7, v9, v7
    v_cos_f32 v33, v7
    v_add_f32 v7, v9, v7
    v_cos_f32 v34, v7
    v_add_f32 v7, v9, v7
    v_cos_f32 v35, v7
    v_add_f32 v7, v9, v7
    v_cos_f32 v36, v7
    v_add_f32 v7, v9, v7
    v_cos_f32 v37, v7
    v_add_f32 v7, v9, v7
    v_cos_f32 v38, v7
    v_add_f32 v7, v9, v7
    v_cos_f32 v39, v7
    v_add_f32 v7, v10, v7
    v_cos_f32 v40, v7
    v_add_f32 v7, v9, v7
    v_cos_f32 v41, v7
    v_add_f32 v7, v9, v7
    v_cos_f32 v42, v7
    v_add_f32 v7, v9, v7
    v_cos_f32 v43, v7
    v_add_f32 v7, v9, v7
    v_cos_f32 v44, v7
    v_add_f32 v7, v9, v7
    v_cos_f32 v45, v7
    v_add_f32 v7, v9, v7
    v_cos_f32 v46, v7
    v_add_f32 v7, v9, v7
    v_cos_f32 v47, v7
    v_mov_b32 v8, 0x3d800000
    v_mov_b32_e64 v9, v8
    v_pk_mul_f32 v[32:33], v[32:33], v[8:9]
    v_pk_mul_f32 v[34:35], v[34:35], v[8:9]
    v_pk_mul_f32 v[36:37], v[36:37], v[8:9]
    v_pk_mul_f32 v[38:39], v[38:39], v[8:9]
    v_pk_mul_f32 v[40:41], v[40:41], v[8:9]
    v_pk_mul_f32 v[42:43], v[42:43], v[8:9]
    v_pk_mul_f32 v[44:45], v[44:45], v[8:9]
    v_pk_mul_f32 v[46:47], v[46:47], v[8:9]
    v_and_b32_e64 v8, 1, v5
    v_mul_u32_u24 v8, 0x8000, v8
    v_lshl_or_b32 v8, v8, 16, v8
    v_cvt_pk_bf16_f32 v128, v32, v33
    v_cvt_pk_bf16_f32 v129, v34, v35
    v_cvt_pk_bf16_f32 v130, v36, v37
    v_cvt_pk_bf16_f32 v131, v38, v39
    v_cvt_pk_bf16_f32 v132, v40, v41
    v_cvt_pk_bf16_f32 v133, v42, v43
    v_cvt_pk_bf16_f32 v134, v44, v45
    v_cvt_pk_bf16_f32 v135, v46, v47
    v_fma_f32 v32, v11, v40, -v32
    v_fma_f32 v33, v11, v41, -v33
    v_fma_f32 v34, v11, v42, -v34
    v_fma_f32 v35, v11, v43, -v35
    v_fma_f32 v36, v11, v44, -v36
    v_fma_f32 v37, v11, v45, -v37
    v_fma_f32 v38, v11, v46, -v38
    v_fma_f32 v39, v11, v47, -v39
    v_cvt_pk_bf16_f32 v136, v32, v33
    v_cvt_pk_bf16_f32 v137, v34, v35
    v_cvt_pk_bf16_f32 v138, v36, v37
    v_cvt_pk_bf16_f32 v139, v38, v39
    v_fma_f32 v40, v11, v32, -v40
    v_fma_f32 v41, v11, v33, -v41
    v_fma_f32 v42, v11, v34, -v42
    v_fma_f32 v43, v11, v35, -v43
    v_fma_f32 v44, v11, v36, -v44
    v_fma_f32 v45, v11, v37, -v45
    v_fma_f32 v46, v11, v38, -v46
    v_fma_f32 v47, v11, v39, -v47
    v_cvt_pk_bf16_f32 v140, v40, v41
    v_cvt_pk_bf16_f32 v141, v42, v43
    v_cvt_pk_bf16_f32 v142, v44, v45
    v_cvt_pk_bf16_f32 v143, v46, v47
    v_fma_f32 v32, v11, v40, -v32
    v_fma_f32 v33, v11, v41, -v33
    v_fma_f32 v34, v11, v42, -v34
    v_fma_f32 v35, v11, v43, -v35
    v_fma_f32 v36, v11, v44, -v36
    v_fma_f32 v37, v11, v45, -v37
    v_fma_f32 v38, v11, v46, -v38
    v_fma_f32 v39, v11, v47, -v39
    v_cvt_pk_bf16_f32 v144, v32, v33
    v_cvt_pk_bf16_f32 v145, v34, v35
    v_cvt_pk_bf16_f32 v146, v36, v37
    v_cvt_pk_bf16_f32 v147, v38, v39
    v_fma_f32 v40, v11, v32, -v40
    v_fma_f32 v41, v11, v33, -v41
    v_fma_f32 v42, v11, v34, -v42
    v_fma_f32 v43, v11, v35, -v43
    v_fma_f32 v44, v11, v36, -v44
    v_fma_f32 v45, v11, v37, -v45
    v_fma_f32 v46, v11, v38, -v46
    v_fma_f32 v47, v11, v39, -v47
    v_cvt_pk_bf16_f32 v148, v40, v41
    v_cvt_pk_bf16_f32 v149, v42, v43
    v_cvt_pk_bf16_f32 v150, v44, v45
    v_cvt_pk_bf16_f32 v151, v46, v47
    v_fma_f32 v32, v11, v40, -v32
    v_fma_f32 v33, v11, v41, -v33
    v_fma_f32 v34, v11, v42, -v34
    v_fma_f32 v35, v11, v43, -v35
    v_fma_f32 v36, v11, v44, -v36
    v_fma_f32 v37, v11, v45, -v37
    v_fma_f32 v38, v11, v46, -v38
    v_fma_f32 v39, v11, v47, -v39
    v_cvt_pk_bf16_f32 v152, v32, v33
    v_cvt_pk_bf16_f32 v153, v34, v35
    v_cvt_pk_bf16_f32 v154, v36, v37
    v_cvt_pk_bf16_f32 v155, v38, v39
    v_fma_f32 v40, v11, v32, -v40
    v_fma_f32 v41, v11, v33, -v41
    v_fma_f32 v42, v11, v34, -v42
    v_fma_f32 v43, v11, v35, -v43
    v_fma_f32 v44, v11, v36, -v44
    v_fma_f32 v45, v11, v37, -v45
    v_fma_f32 v46, v11, v38, -v46
    v_fma_f32 v47, v11, v39, -v47
    v_cvt_pk_bf16_f32 v156, v40, v41
    v_cvt_pk_bf16_f32 v157, v42, v43
    v_cvt_pk_bf16_f32 v158, v44, v45
    v_cvt_pk_bf16_f32 v159, v46, v47
    v_xor_b32 v160, v8, v128
    v_xor_b32 v161, v8, v129
    v_xor_b32 v162, v8, v130
    v_xor_b32 v163, v8, v131
    v_xor_b32 v164, v8, v132
    v_xor_b32 v165, v8, v133
    v_xor_b32 v166, v8, v134
    v_xor_b32 v167, v8, v135
    v_xor_b32 v168, v8, v136
    v_xor_b32 v169, v8, v137
    v_xor_b32 v170, v8, v138
    v_xor_b32 v171, v8, v139
    v_xor_b32 v172, v8, v140
    v_xor_b32 v173, v8, v141
    v_xor_b32 v174, v8, v142
    v_xor_b32 v175, v8, v143
    v_xor_b32 v176, v8, v144
    v_xor_b32 v177, v8, v145
    v_xor_b32 v178, v8, v146
    v_xor_b32 v179, v8, v147
    v_xor_b32 v180, v8, v148
    v_xor_b32 v181, v8, v149
    v_xor_b32 v182, v8, v150
    v_xor_b32 v183, v8, v151
    v_xor_b32 v184, v8, v152
    v_xor_b32 v185, v8, v153
    v_xor_b32 v186, v8, v154
    v_xor_b32 v187, v8, v155
    v_xor_b32 v188, v8, v156
    v_xor_b32 v189, v8, v157
    v_xor_b32 v190, v8, v158
    v_xor_b32 v191, v8, v159
    s_setpc_b64 s[6:7]
GEN_TW:
    s_lshl_b32 s30, s24, 4
    v_add_u32 v72, s30, v13
    v_cvt_f32_u32 v72, v72
    v_mul_f32 v72, 0x3a000000, v72
    v_lshlrev_b32 v73, 2, v14
    v_cvt_f32_u32 v73, v73
    v_mul_f32_e64 v73, v73, v72
    v_mul_f32 v74, 0x41500000, v72
    v_cos_f32 v160, v73
    v_sin_f32 v168, v73
    v_add_f32 v73, v72, v73
    v_cos_f32 v161, v73
    v_sin_f32 v169, v73
    v_add_f32 v73, v72, v73
    v_cos_f32 v162, v73
    v_sin_f32 v170, v73
    v_add_f32 v73, v72, v73
    v_cos_f32 v163, v73
    v_sin_f32 v171, v73
    v_add_f32 v73, v74, v73
    v_cos_f32 v164, v73
    v_sin_f32 v172, v73
    v_add_f32 v73, v72, v73
    v_cos_f32 v165, v73
    v_sin_f32 v173, v73
    v_add_f32 v73, v72, v73
    v_cos_f32 v166, v73
    v_sin_f32 v174, v73
    v_add_f32 v73, v72, v73
    v_cos_f32 v167, v73
    v_sin_f32_e64 v175, v73
    v_lshl_add_u32 v72, v14, 2, s30
    v_cvt_f32_u32 v72, v72
    v_cvt_f32_u32 v74, v13
    v_mul_f32 v74, 0x3a000000, v74
    v_mul_f32 v73, v72, v74
    v_cos_f32 v176, v73
    v_sin_f32 v184, v73
    v_add_f32 v73, v74, v73
    v_cos_f32 v177, v73
    v_sin_f32 v185, v73
    v_add_f32 v73, v74, v73
    v_cos_f32 v178, v73
    v_sin_f32 v186, v73
    v_add_f32 v73, v74, v73
    v_cos_f32 v179, v73
    v_sin_f32 v187, v73
    v_add_f32 v74, 0x3c000000, v74
    v_mul_f32 v73, v72, v74
    v_cos_f32 v180, v73
    v_sin_f32 v188, v73
    v_add_f32 v73, v74, v73
    v_cos_f32 v181, v73
    v_sin_f32 v189, v73
    v_add_f32 v73, v74, v73
    v_cos_f32 v182, v73
    v_sin_f32 v190, v73
    v_add_f32 v73, v74, v73
    v_cos_f32 v183, v73
    v_sin_f32 v191, v73
    v_mov_b32 v72, 0x3a000000
    v_mov_b32_e64 v73, v72
    v_pk_mul_f32 v[176:177], v[176:177], v[72:73]
    v_pk_mul_f32 v[178:179], v[178:179], v[72:73]
    v_pk_mul_f32 v[180:181], v[180:181], v[72:73]
    v_pk_mul_f32 v[182:183], v[182:183], v[72:73]
    v_pk_mul_f32 v[184:185], v[184:185], v[72:73]
    v_pk_mul_f32 v[186:187], v[186:187], v[72:73]
    v_pk_mul_f32 v[188:189], v[188:189], v[72:73]
    v_pk_mul_f32 v[190:191], v[190:191], v[72:73]
    s_nop 1
    s_setpc_b64 s[6:7]
GEN_MAT:
    s_lshl_b32 s30, s24, 4
    v_add_u32 v72, s30, v13
    v_and_b32_e64 v78, 1, v72
    v_mul_u32_u24 v78, 0x8000, v78
    v_lshl_or_b32 v78, v78, 16, v78
    v_cvt_f32_u32_e64 v72, v72
    v_mul_f32 v72, 0x3c800000, v72
    v_lshlrev_b32 v73, 3, v14
    v_cvt_f32_u32 v73, v73
    v_mul_f32 v73, v73, v72
    v_cos_f32 v74, v73
    v_sin_f32 v76, v73
    v_add_f32 v73, v72, v73
    v_cos_f32 v75, v73
    v_sin_f32 v77, v73
    v_add_f32_e64 v73, v72, v73
    v_cvt_pk_bf16_f32 v128, v74, v75
    v_cvt_pk_bf16_f32 v136, v76, v77
    v_cos_f32 v74, v73
    v_sin_f32 v76, v73
    v_add_f32 v73, v72, v73
    v_cos_f32 v75, v73
    v_sin_f32 v77, v73
    v_add_f32 v73, v72, v73
    v_cvt_pk_bf16_f32 v129, v74, v75
    v_cvt_pk_bf16_f32 v137, v76, v77
    v_cos_f32 v74, v73
    v_sin_f32 v76, v73
    v_add_f32 v73, v72, v73
    v_cos_f32 v75, v73
    v_sin_f32 v77, v73
    v_add_f32 v73, v72, v73
    v_cvt_pk_bf16_f32 v130, v74, v75
    v_cvt_pk_bf16_f32 v138, v76, v77
    v_cos_f32 v74, v73
    v_sin_f32 v76, v73
    v_add_f32 v73, v72, v73
    v_cos_f32 v75, v73
    v_sin_f32 v77, v73
    v_add_f32 v73, v72, v73
    v_cvt_pk_bf16_f32 v131, v74, v75
    v_cvt_pk_bf16_f32 v139, v76, v77
    v_xor_b32 v132, v78, v128
    v_xor_b32 v140, v78, v136
    v_xor_b32 v133, v78, v129
    v_xor_b32 v141, v78, v137
    v_xor_b32 v134, v78, v130
    v_xor_b32 v142, v78, v138
    v_xor_b32 v135, v78, v131
    v_xor_b32 v143, v78, v139
    v_cvt_f32_u32_e64 v72, v13
    v_mul_f32 v72, 0x3d000000, v72
    v_lshlrev_b32 v73, 2, v14
    v_cvt_f32_u32 v73, v73
    v_mul_f32_e64 v73, v73, v72
    v_mul_f32 v79, 0x41500000, v72
    v_cos_f32 v74, v73
    v_sin_f32 v76, v73
    v_add_f32 v73, v72, v73
    v_cos_f32 v75, v73
    v_sin_f32 v77, v73
    v_add_f32 v73, v72, v73
    v_cvt_pk_bf16_f32 v144, v74, v75
    v_cvt_pk_bf16_f32 v152, v76, v77
    v_cos_f32 v74, v73
    v_sin_f32 v76, v73
    v_add_f32 v73, v72, v73
    v_cos_f32 v75, v73
    v_sin_f32 v77, v73
    v_add_f32 v73, v79, v73
    v_cvt_pk_bf16_f32 v145, v74, v75
    v_cvt_pk_bf16_f32 v153, v76, v77
    v_cos_f32 v74, v73
    v_sin_f32 v76, v73
    v_add_f32 v73, v72, v73
    v_cos_f32 v75, v73
    v_sin_f32 v77, v73
    v_add_f32 v73, v72, v73
    v_cvt_pk_bf16_f32 v146, v74, v75
    v_cvt_pk_bf16_f32 v154, v76, v77
    v_cos_f32 v74, v73
    v_sin_f32 v76, v73
    v_add_f32 v73, v72, v73
    v_cos_f32 v75, v73
    v_sin_f32 v77, v73
    v_add_f32 v73, v72, v73
    v_cvt_pk_bf16_f32 v147, v74, v75
    v_cvt_pk_bf16_f32 v155, v76, v77
    v_xor_b32 v148, 0x80000000, v144
    v_xor_b32 v156, 0x80000000, v152
    v_xor_b32 v149, 0x80000000, v145
    v_xor_b32 v157, 0x80000000, v153
    v_xor_b32 v150, 0x80000000, v146
    v_xor_b32 v158, 0x80000000, v154
    v_xor_b32 v151, 0x80000000, v147
    v_xor_b32 v159, 0x80000000, v155
    s_nop 1
    s_setpc_b64 s[6:7]
rty0_34:
    s_sub_u32 s58, s58, 1
    s_cbranch_scc0 go_108
    s_mov_b32 s58, 0
    s_branch bk0_35_ok
go_108:
    s_waitcnt vmcnt(0) lgkmcnt(0)
    s_add_u32 s30, s59, 0
    s_add_u32 m0, s31, 0
    s_nop 0
    buffer_load_dwordx4 v12, s[8:11], s30 offen offset:0 sc1 lds
    buffer_load_dwordx4 v12, s[8:11], s30 offen offset:1024 sc1 lds
    buffer_load_dwordx4 v12, s[8:11], s30 offen offset:2048 sc1 lds
    buffer_load_dwordx4 v12, s[8:11], s30 offen offset:3072 sc1 lds
    s_add_u32 s30, s59, 4096
    s_add_u32 m0, s31, 4096
    s_nop 0
    s_nop 0
    buffer_load_dwordx4 v12, s[8:11], s30 offen offset:0 sc1 lds
    buffer_load_dwordx4 v12, s[8:11], s30 offen offset:1024 sc1 lds
    buffer_load_dwordx4 v12, s[8:11], s30 offen offset:2048 sc1 lds
    buffer_load_dwordx4 v12, s[8:11], s30 offen offset:3072 sc1 lds
    s_add_u32 s30, s59, 8192
    s_add_u32 m0, s48, 65536
    s_nop 0
    s_nop 0
    buffer_load_dwordx4 v12, s[8:11], s30 offen offset:0 sc1 lds
    buffer_load_dwordx4 v12, s[8:11], s30 offen offset:1024 sc1 lds
    buffer_load_dwordx4 v12, s[8:11], s30 offen offset:2048 sc1 lds
    buffer_load_dwordx4 v12, s[8:11], s30 offen offset:3072 sc1 lds
    s_add_u32 s30, s59, 12288
    s_add_u32 m0, s48, 69632
    s_nop 0
    buffer_load_dwordx4 v12, s[8:11], s30 offen offset:0 sc1 lds
    buffer_load_dwordx4 v12, s[8:11], s30 offen offset:1024 sc1 lds
    buffer_load_dwordx4 v12, s[8:11], s30 offen offset:2048 sc1 lds
    buffer_load_dwordx4 v12, s[8:11], s30 offen offset:3072 sc1 lds
    s_waitcnt vmcnt(0)
    ds_read_b64_tr_b16 v[32:33], v8 offset:0
    ds_read_b64_tr_b16 v[34:35], v8 offset:512
    ds_read_b64_tr_b16 v[36:37], v8 offset:1024
    ds_read_b64_tr_b16 v[38:39], v8 offset:1536
    ds_read_b64_tr_b16 v[40:41], v8 offset:2048
    ds_read_b64_tr_b16 v[42:43], v8 offset:2560
    ds_read_b64_tr_b16 v[44:45], v8 offset:3072
    ds_read_b64_tr_b16 v[46:47], v8 offset:3584
    s_branch bk0_35
rty1_36:
    s_sub_u32 s58, s58, 1
    s_cbranch_scc0 go_109
    s_mov_b32 s58, 0
    s_branch bk1_37_ok
go_109:
    s_waitcnt vmcnt(0) lgkmcnt(0)
    s_add_u32 s30, s59, 4096
    s_add_u32 m0, s31, 4096
    s_nop 0
    s_nop 0
    buffer_load_dwordx4 v12, s[8:11], s30 offen offset:0 sc1 lds
    buffer_load_dwordx4 v12, s[8:11], s30 offen offset:1024 sc1 lds
    buffer_load_dwordx4 v12, s[8:11], s30 offen offset:2048 sc1 lds
    buffer_load_dwordx4 v12, s[8:11], s30 offen offset:3072 sc1 lds
    s_add_u32 s30, s59, 8192
    s_add_u32 m0, s48, 65536
    s_nop 0
    s_nop 0
    buffer_load_dwordx4 v12, s[8:11], s30 offen offset:0 sc1 lds
    buffer_load_dwordx4 v12, s[8:11], s30 offen offset:1024 sc1 lds
    buffer_load_dwordx4 v12, s[8:11], s30 offen offset:2048 sc1 lds
    buffer_load_dwordx4 v12, s[8:11], s30 offen offset:3072 sc1 lds
    s_add_u32 s30, s59, 12288
    s_add_u32 m0, s48, 69632
    s_nop 0
    s_nop 0
    buffer_load_dwordx4 v12, s[8:11], s30 offen offset:0 sc1 lds
    buffer_load_dwordx4 v12, s[8:11], s30 offen offset:1024 sc1 lds
    buffer_load_dwordx4 v12, s[8:11], s30 offen offset:2048 sc1 lds
    buffer_load_dwordx4 v12, s[8:11], s30 offen offset:3072 sc1 lds
    s_add_u32 s30, s59, 16384
    s_add_u32 m0, s31, 8192
    s_nop 0
    s_nop 0
    buffer_load_dwordx4 v12, s[8:11], s30 offen offset:0 sc1 lds
    buffer_load_dwordx4 v12, s[8:11], s30 offen offset:1024 sc1 lds
    buffer_load_dwordx4 v12, s[8:11], s30 offen offset:2048 sc1 lds
    buffer_load_dwordx4 v12, s[8:11], s30 offen offset:3072 sc1 lds
    s_add_u32 s30, s59, 20480
    s_add_u32 m0, s31, 12288
    s_nop 0
    buffer_load_dwordx4 v12, s[8:11], s30 offen offset:0 sc1 lds
    buffer_load_dwordx4 v12, s[8:11], s30 offen offset:1024 sc1 lds
    buffer_load_dwordx4 v12, s[8:11], s30 offen offset:2048 sc1 lds
    buffer_load_dwordx4 v12, s[8:11], s30 offen offset:3072 sc1 lds
    s_waitcnt vmcnt(0)
    ds_read_b64_tr_b16 v[72:73], v8 offset:4096
    ds_read_b64_tr_b16 v[74:75], v8 offset:4608
    ds_read_b64_tr_b16 v[76:77], v8 offset:5120
    ds_read_b64_tr_b16 v[78:79], v8 offset:5632
    ds_read_b64_tr_b16 v[80:81], v8 offset:6144
    ds_read_b64_tr_b16 v[82:83], v8 offset:6656
    ds_read_b64_tr_b16 v[84:85], v8 offset:7168
    ds_read_b64_tr_b16 v[86:87], v8 offset:7680
    s_branch bk1_37
rty2_38:
    s_sub_u32 s58, s58, 1
    s_cbranch_scc0 go_110
    s_mov_b32 s58, 0
    s_branch bk2_39_ok
go_110:
    s_waitcnt vmcnt(0) lgkmcnt(0)
    s_add_u32 s30, s59, 8192
    s_add_u32 m0, s48, 65536
    s_nop 0
    s_nop 0
    buffer_load_dwordx4 v12, s[8:11], s30 offen offset:0 sc1 lds
    buffer_load_dwordx4 v12, s[8:11], s30 offen offset:1024 sc1 lds
    buffer_load_dwordx4 v12, s[8:11], s30 offen offset:2048 sc1 lds
    buffer_load_dwordx4 v12, s[8:11], s30 offen offset:3072 sc1 lds
    s_add_u32 s30, s59, 12288
    s_add_u32 m0, s48, 69632
    s_nop 0
    s_nop 0
    buffer_load_dwordx4 v12, s[8:11], s30 offen offset:0 sc1 lds
    buffer_load_dwordx4 v12, s[8:11], s30 offen offset:1024 sc1 lds
    buffer_load_dwordx4 v12, s[8:11], s30 offen offset:2048 sc1 lds
    buffer_load_dwordx4 v12, s[8:11], s30 offen offset:3072 sc1 lds
    s_add_u32 s30, s59, 16384
    s_add_u32 m0, s31, 8192
    s_nop 0
    s_nop 0
    buffer_load_dwordx4 v12, s[8:11], s30 offen offset:0 sc1 lds
    buffer_load_dwordx4 v12, s[8:11], s30 offen offset:1024 sc1 lds
    buffer_load_dwordx4 v12, s[8:11], s30 offen offset:2048 sc1 lds
    buffer_load_dwordx4 v12, s[8:11], s30 offen offset:3072 sc1 lds
    s_add_u32 s30, s59, 20480
    s_add_u32 m0, s31, 12288
    s_nop 0
    buffer_load_dwordx4 v12, s[8:11], s30 offen offset:0 sc1 lds
    buffer_load_dwordx4 v12, s[8:11], s30 offen offset:1024 sc1 lds
    buffer_load_dwordx4 v12, s[8:11], s30 offen offset:2048 sc1 lds
    buffer_load_dwordx4 v12, s[8:11], s30 offen offset:3072 sc1 lds
    s_add_u32 s30, s59, 24576
    s_add_u32 m0, s31, 0
    s_nop 0
    buffer_load_dwordx4 v12, s[8:11], s30 offen offset:0 sc1 lds
    buffer_load_dwordx4 v12, s[8:11], s30 offen offset:1024 sc1 lds
    buffer_load_dwordx4 v12, s[8:11], s30 offen offset:2048 sc1 lds
    buffer_load_dwordx4 v12, s[8:11], s30 offen offset:3072 sc1 lds
    s_waitcnt vmcnt(0)
    ds_read_b64_tr_b16 v[32:33], v7 offset:0
    ds_read_b64_tr_b16 v[34:35], v7 offset:512
    ds_read_b64_tr_b16 v[36:37], v7 offset:1024
    ds_read_b64_tr_b16 v[38:39], v7 offset:1536
    ds_read_b64_tr_b16 v[40:41], v7 offset:2048
    ds_read_b64_tr_b16 v[42:43], v7 offset:2560
    ds_read_b64_tr_b16 v[44:45], v7 offset:3072
    ds_read_b64_tr_b16 v[46:47], v7 offset:3584
    s_branch bk2_39
rty3_40:
    s_sub_u32 s58, s58, 1
    s_cbranch_scc0 go_111
    s_mov_b32 s58, 0
    s_branch bk3_41_ok
go_111:
    s_waitcnt vmcnt(0) lgkmcnt(0)
    s_add_u32 s30, s59, 12288
    s_add_u32 m0, s48, 69632
    s_nop 0
    s_nop 0
    buffer_load_dwordx4 v12, s[8:11], s30 offen offset:0 sc1 lds
    buffer_load_dwordx4 v12, s[8:11], s30 offen offset:1024 sc1 lds
    buffer_load_dwordx4 v12, s[8:11], s30 offen offset:2048 sc1 lds
    buffer_load_dwordx4 v12, s[8:11], s30 offen offset:3072 sc1 lds
    s_add_u32 s30, s59, 16384
    s_add_u32 m0, s31, 8192
    s_nop 0
    s_nop 0
    buffer_load_dwordx4 v12, s[8:11], s30 offen offset:0 sc1 lds
    buffer_load_dwordx4 v12, s[8:11], s30 offen offset:1024 sc1 lds
    buffer_load_dwordx4 v12, s[8:11], s30 offen offset:2048 sc1 lds
    buffer_load_dwordx4 v12, s[8:11], s30 offen offset:3072 sc1 lds
    s_add_u32 s30, s59, 20480
    s_add_u32 m0, s31, 12288
    s_nop 0
    buffer_load_dwordx4 v12, s[8:11], s30 offen offset:0 sc1 lds
    buffer_load_dwordx4 v12, s[8:11], s30 offen offset:1024 sc1 lds
    buffer_load_dwordx4 v12, s[8:11], s30 offen offset:2048 sc1 lds
    buffer_load_dwordx4 v12, s[8:11], s30 offen offset:3072 sc1 lds
    s_add_u32 s30, s59, 24576
    s_add_u32 m0, s31, 0
    s_nop 0
    s_nop 0
    buffer_load_dwordx4 v12, s[8:11], s30 offen offset:0 sc1 lds
    buffer_load_dwordx4 v12, s[8:11], s30 offen offset:1024 sc1 lds
    buffer_load_dwordx4 v12, s[8:11], s30 offen offset:2048 sc1 lds
    buffer_load_dwordx4 v12, s[8:11], s30 offen offset:3072 sc1 lds
    s_add_u32 s30, s59, 28672
    s_add_u32 m0, s31, 4096
    s_nop 0
    buffer_load_dwordx4 v12, s[8:11], s30 offen offset:0 sc1 lds
    buffer_load_dwordx4 v12, s[8:11], s30 offen offset:1024 sc1 lds
    buffer_load_dwordx4 v12, s[8:11], s30 offen offset:2048 sc1 lds
    buffer_load_dwordx4 v12, s[8:11], s30 offen offset:3072 sc1 lds
    s_waitcnt vmcnt(0)
    ds_read_b64_tr_b16 v[72:73], v7 offset:4096
    ds_read_b64_tr_b16 v[74:75], v7 offset:4608
    ds_read_b64_tr_b16 v[76:77], v7 offset:5120
    ds_read_b64_tr_b16 v[78:79], v7 offset:5632
    ds_read_b64_tr_b16 v[80:81], v7 offset:6144
    ds_read_b64_tr_b16 v[82:83], v7 offset:6656
    ds_read_b64_tr_b16 v[84:85], v7 offset:7168
    ds_read_b64_tr_b16 v[86:87], v7 offset:7680
    s_branch bk3_41
rty4_42:
    s_sub_u32 s58, s58, 1
    s_cbranch_scc0 go_112
    s_mov_b32 s58, 0
    s_branch bk4_43_ok
go_112:
    s_waitcnt vmcnt(0) lgkmcnt(0)
    s_add_u32 s30, s59, 16384
    s_add_u32 m0, s31, 8192
    s_nop 0
    s_nop 0
    buffer_load_dwordx4 v12, s[8:11], s30 offen offset:0 sc1 lds
    buffer_load_dwordx4 v12, s[8:11], s30 offen offset:1024 sc1 lds
    buffer_load_dwordx4 v12, s[8:11], s30 offen offset:2048 sc1 lds
    buffer_load_dwordx4 v12, s[8:11], s30 offen offset:3072 sc1 lds
    s_add_u32 s30, s59, 20480
    s_add_u32 m0, s31, 12288
    s_nop 0
    buffer_load_dwordx4 v12, s[8:11], s30 offen offset:0 sc1 lds
    buffer_load_dwordx4 v12, s[8:11], s30 offen offset:1024 sc1 lds
    buffer_load_dwordx4 v12, s[8:11], s30 offen offset:2048 sc1 lds
    buffer_load_dwordx4 v12, s[8:11], s30 offen offset:3072 sc1 lds
    s_add_u32 s30, s59, 24576
    s_add_u32 m0, s31, 0
    s_nop 0
    s_nop 0
    buffer_load_dwordx4 v12, s[8:11], s30 offen offset:0 sc1 lds
    buffer_load_dwordx4 v12, s[8:11], s30 offen offset:1024 sc1 lds
    buffer_load_dwordx4 v12, s[8:11], s30 offen offset:2048 sc1 lds
    buffer_load_dwordx4 v12, s[8:11], s30 offen offset:3072 sc1 lds
    s_add_u32 s30, s59, 28672
    s_add_u32 m0, s31, 4096
    s_nop 0
    buffer_load_dwordx4 v12, s[8:11], s30 offen offset:0 sc1 lds
    buffer_load_dwordx4 v12, s[8:11], s30 offen offset:1024 sc1 lds
    buffer_load_dwordx4 v12, s[8:11], s30 offen offset:2048 sc1 lds
    buffer_load_dwordx4 v12, s[8:11], s30 offen offset:3072 sc1 lds
    s_waitcnt vmcnt(0)
    ds_read_b64_tr_b16 v[32:33], v8 offset:8192
    ds_read_b64_tr_b16 v[34:35], v8 offset:8704
    ds_read_b64_tr_b16 v[36:37], v8 offset:9216
    ds_read_b64_tr_b16 v[38:39], v8 offset:9728
    ds_read_b64_tr_b16 v[40:41], v8 offset:10240
    ds_read_b64_tr_b16 v[42:43], v8 offset:10752
    ds_read_b64_tr_b16 v[44:45], v8 offset:11264
    ds_read_b64_tr_b16 v[46:47], v8 offset:11776
    s_branch bk4_43
rty5_44:
    s_sub_u32 s58, s58, 1
    s_cbranch_scc0 go_113
    s_mov_b32 s58, 0
    s_branch bk5_45_ok
go_113:
    s_waitcnt vmcnt(0) lgkmcnt(0)
    s_add_u32 s30, s59, 20480
    s_add_u32 m0, s31, 12288
    s_nop 0
    buffer_load_dwordx4 v12, s[8:11], s30 offen offset:0 sc1 lds
    buffer_load_dwordx4 v12, s[8:11], s30 offen offset:1024 sc1 lds
    buffer_load_dwordx4 v12, s[8:11], s30 offen offset:2048 sc1 lds
    buffer_load_dwordx4 v12, s[8:11], s30 offen offset:3072 sc1 lds
    s_add_u32 s30, s59, 24576
    s_add_u32 m0, s31, 0
    s_nop 0
    s_nop 0
    buffer_load_dwordx4 v12, s[8:11], s30 offen offset:0 sc1 lds
    buffer_load_dwordx4 v12, s[8:11], s30 offen offset:1024 sc1 lds
    buffer_load_dwordx4 v12, s[8:11], s30 offen offset:2048 sc1 lds
    buffer_load_dwordx4 v12, s[8:11], s30 offen offset:3072 sc1 lds
    s_add_u32 s30, s59, 28672
    s_add_u32 m0, s31, 4096
    s_nop 0
    buffer_load_dwordx4 v12, s[8:11], s30 offen offset:0 sc1 lds
    buffer_load_dwordx4 v12, s[8:11], s30 offen offset:1024 sc1 lds
    buffer_load_dwordx4 v12, s[8:11], s30 offen offset:2048 sc1 lds
    buffer_load_dwordx4 v12, s[8:11], s30 offen offset:3072 sc1 lds
    s_waitcnt vmcnt(0)
    ds_read_b64_tr_b16 v[72:73], v8 offset:12288
    ds_read_b64_tr_b16 v[74:75], v8 offset:12800
    ds_read_b64_tr_b16 v[76:77], v8 offset:13312
    ds_read_b64_tr_b16 v[78:79], v8 offset:13824
    ds_read_b64_tr_b16 v[80:81], v8 offset:14336
    ds_read_b64_tr_b16 v[82:83], v8 offset:14848
    ds_read_b64_tr_b16 v[84:85], v8 offset:15360
    ds_read_b64_tr_b16 v[86:87], v8 offset:15872
    s_branch bk5_45
rty6_46:
    s_sub_u32 s58, s58, 1
    s_cbranch_scc0 go_114
    s_mov_b32 s58, 0
    s_branch bk6_47_ok
go_114:
    s_waitcnt vmcnt(0) lgkmcnt(0)
    s_add_u32 s30, s59, 24576
    s_add_u32 m0, s31, 0
    s_nop 0
    buffer_load_dwordx4 v12, s[8:11], s30 offen offset:0 sc1 lds
    buffer_load_dwordx4 v12, s[8:11], s30 offen offset:1024 sc1 lds
    buffer_load_dwordx4 v12, s[8:11], s30 offen offset:2048 sc1 lds
    buffer_load_dwordx4 v12, s[8:11], s30 offen offset:3072 sc1 lds
    s_add_u32 s30, s59, 28672
    s_add_u32 m0, s31, 4096
    s_nop 0
    buffer_load_dwordx4 v12, s[8:11], s30 offen offset:0 sc1 lds
    buffer_load_dwordx4 v12, s[8:11], s30 offen offset:1024 sc1 lds
    buffer_load_dwordx4 v12, s[8:11], s30 offen offset:2048 sc1 lds
    buffer_load_dwordx4 v12, s[8:11], s30 offen offset:3072 sc1 lds
    s_waitcnt vmcnt(0)
    ds_read_b64_tr_b16 v[32:33], v8 offset:0
    ds_read_b64_tr_b16 v[34:35], v8 offset:512
    ds_read_b64_tr_b16 v[36:37], v8 offset:1024
    ds_read_b64_tr_b16 v[38:39], v8 offset:1536
    ds_read_b64_tr_b16 v[40:41], v8 offset:2048
    ds_read_b64_tr_b16 v[42:43], v8 offset:2560
    ds_read_b64_tr_b16 v[44:45], v8 offset:3072
    ds_read_b64_tr_b16 v[46:47], v8 offset:3584
    s_branch bk6_47
rty7_48:
    s_sub_u32 s58, s58, 1
    s_cbranch_scc0 go_115
    s_mov_b32 s58, 0
    s_branch bk7_49_ok
go_115:
    s_waitcnt vmcnt(0) lgkmcnt(0)
    s_add_u32 s30, s59, 28672
    s_add_u32 m0, s31, 4096
    s_nop 0
    buffer_load_dwordx4 v12, s[8:11], s30 offen offset:0 sc1 lds
    buffer_load_dwordx4 v12, s[8:11], s30 offen offset:1024 sc1 lds
    buffer_load_dwordx4 v12, s[8:11], s30 offen offset:2048 sc1 lds
    buffer_load_dwordx4 v12, s[8:11], s30 offen offset:3072 sc1 lds
    s_waitcnt vmcnt(0)
    ds_read_b64_tr_b16 v[72:73], v8 offset:4096
    ds_read_b64_tr_b16 v[74:75], v8 offset:4608
    ds_read_b64_tr_b16 v[76:77], v8 offset:5120
    ds_read_b64_tr_b16 v[78:79], v8 offset:5632
    ds_read_b64_tr_b16 v[80:81], v8 offset:6144
    ds_read_b64_tr_b16 v[82:83], v8 offset:6656
    ds_read_b64_tr_b16 v[84:85], v8 offset:7168
    ds_read_b64_tr_b16 v[86:87], v8 offset:7680
    s_branch bk7_49
ex0_56:
    v_mfma_f32_32x32x16_bf16 v[112:127], v[76:79], v[68:71], v[112:127]
    s_branch pl1_60
ex1_57:
    v_mfma_f32_32x32x16_bf16 v[112:127], v[84:87], v[68:71], v[112:127]
    s_branch pl2_61
ex2_58:
    v_mfma_f32_32x32x16_bf16 v[112:127], v[76:79], v[68:71], v[112:127]
    s_branch pl3_62
pl0_59:
pl1_60:
pl2_61:
pl3_62:
pl4_63:
    s_branch adone_55
ex0_70:
    v_mfma_f32_32x32x16_bf16 v[112:127], v[76:79], v[68:71], v[112:127]
    s_branch pl1_84
ex1_73:
    v_mfma_f32_32x32x16_bf16 v[112:127], v[84:87], v[68:71], v[112:127]
    s_branch pl2_85
ex2_75:
    v_mfma_f32_32x32x16_bf16 v[112:127], v[76:79], v[68:71], v[112:127]
    s_branch pl3_86
ex3_77:
    v_mfma_f32_32x32x16_bf16 v[112:127], v[84:87], v[68:71], v[112:127]
    s_branch pl4_87
ex4_79:
    v_mfma_f32_32x32x16_bf16 v[112:127], v[76:79], v[68:71], v[112:127]
    s_branch pl5_88
ex5_81:
    v_mfma_f32_32x32x16_bf16 v[112:127], v[84:87], v[68:71], v[112:127]
    s_branch pl6_89
ex6_82:
    v_mfma_f32_32x32x16_bf16 v[112:127], v[76:79], v[68:71], v[112:127]
    s_branch pl7_90
pl0_83:
    s_cmp_lg_u32 s55, 0
    s_cbranch_scc1 nf_116
    s_add_u32 s33, s59, 6291456
    buffer_store_dwordx4 v[24:27], v15, s[8:11], s33 offen sc1
nf_116:
    s_cmp_ge_u32 s24, 4
    s_cbranch_scc1 npl_117
    buffer_load_dwordx4 v[192:195], v6, s[8:11], s60 offen offset:0 sc1
    buffer_load_dwordx4 v[196:199], v6, s[8:11], s60 offen offset:1024 sc1
    buffer_load_dwordx4 v[200:203], v6, s[8:11], s60 offen offset:2048 sc1
npl_117:
pl1_84:
    s_cmp_lg_u32 s55, 0
    s_cbranch_scc1 nf_118
    s_add_u32 s33, s59, 27262976
    buffer_store_dwordx4 v[24:27], v15, s[8:11], s33 offen sc1
nf_118:
    s_cmp_ge_u32 s24, 4
    s_cbranch_scc1 npl_119
    buffer_load_dwordx4 v[204:207], v6, s[8:11], s60 offen offset:3072 sc1
    buffer_load_dwordx4 v[208:211], v12, s[8:11], s60 offen offset:0 sc1
    buffer_load_dwordx4 v[212:215], v12, s[8:11], s60 offen offset:1024 sc1
npl_119:
pl2_85:
    s_cmp_ge_u32 s24, 4
    s_cbranch_scc1 npl_120
    buffer_load_dwordx4 v[216:219], v12, s[8:11], s60 offen offset:2048 sc1
    buffer_load_dwordx4 v[220:223], v12, s[8:11], s60 offen offset:3072 sc1
    s_add_u32 s60, s60, 8192
    buffer_load_dwordx4 v[224:227], v6, s[8:11], s60 offen offset:0 sc1
npl_120:
pl3_86:
    s_cmp_ge_u32 s24, 4
    s_cbranch_scc1 npl_121
    buffer_load_dwordx4 v[228:231], v6, s[8:11], s60 offen offset:1024 sc1
    buffer_load_dwordx4 v[232:235], v6, s[8:11], s60 offen offset:2048 sc1
    buffer_load_dwordx4 v[236:239], v6, s[8:11], s60 offen offset:3072 sc1
npl_121:
pl4_87:
    s_cmp_ge_u32 s24, 4
    s_cbranch_scc1 npl_122
    buffer_load_dwordx4 v[240:243], v12, s[8:11], s60 offen offset:0 sc1
    buffer_load_dwordx4 v[244:247], v12, s[8:11], s60 offen offset:1024 sc1
npl_122:
pl5_88:
    s_cmp_ge_u32 s24, 4
    s_cbranch_scc1 npl_123
    buffer_load_dwordx4 v[248:251], v12, s[8:11], s60 offen offset:2048 sc1
    buffer_load_dwordx4 v[252:255], v12, s[8:11], s60 offen offset:3072 sc1
npl_123:
pl6_89:
pl7_90:
pl8_91:
    s_branch adone_67
p2skip_66:
    s_branch pl0_83
fallback_92:
    s_waitcnt lgkmcnt(0)
    v_mov_b32 v15, 0xff61b1e6
    v_mov_b32 v112, 0
    v_mov_b32 v113, 0
    v_mov_b32 v114, 0
    v_mov_b32 v115, 0
    v_mov_b32 v116, 0
    v_mov_b32 v117, 0
    v_mov_b32 v118, 0
    v_mov_b32 v119, 0
    v_mov_b32 v120, 0
    v_mov_b32 v121, 0
    v_mov_b32 v122, 0
    v_mov_b32 v123, 0
    v_mov_b32 v124, 0
    v_mov_b32 v125, 0
    v_mov_b32 v126, 0
    v_mov_b32 v127, 0
    s_add_u32 s30, s63, 1
    v_add_u32 v4, 24576, v20
    v_add_u32 v5, 24576, v21
    v_mov_b32 v48, v96
    v_mov_b32 v49, v97
    v_mov_b32 v50, v98
    v_mov_b32 v51, v99
    v_mov_b32 v52, v100
    v_mov_b32 v53, v101
    v_mov_b32 v54, v102
    v_mov_b32 v55, v103
    v_mov_b32 v56, v104
    v_mov_b32 v57, v105
    v_mov_b32 v58, v106
    v_mov_b32 v59, v107
    v_mov_b32 v60, v108
    v_mov_b32 v61, v109
    v_mov_b32 v62, v110
    v_mov_b32 v63, v111
fl_124:
    ds_read_b128 v[88:91], v4
    s_waitcnt lgkmcnt(0)
    v_mfma_f32_32x32x16_bf16 v[32:47], v[88:91], v[16:19], v[48:63]
    v_add_u32 v4, 4294959104, v4
    v_add_u32 v5, 4294959104, v5
    s_nop 9
    v_max3_f32 v15, v32, v33, v15
    v_max3_f32 v15, v34, v35, v15
    v_max3_f32 v15, v36, v37, v15
    v_max3_f32 v15, v38, v39, v15
    v_max3_f32 v15, v40, v41, v15
    v_max3_f32 v15, v42, v43, v15
    v_max3_f32 v15, v44, v45, v15
    v_max3_f32 v15, v46, v47, v15
    v_mov_b32 v48, 0
    v_mov_b32 v49, 0
    v_mov_b32 v50, 0
    v_mov_b32 v51, 0
    v_mov_b32 v52, 0
    v_mov_b32 v53, 0
    v_mov_b32 v54, 0
    v_mov_b32 v55, 0
    v_mov_b32 v56, 0
    v_mov_b32 v57, 0
    v_mov_b32 v58, 0
    v_mov_b32 v59, 0
    v_mov_b32 v60, 0
    v_mov_b32 v61, 0
    v_mov_b32 v62, 0
    v_mov_b32 v63, 0
    s_sub_u32 s30, s30, 1
    s_cmp_lg_u32 s30, 0
    s_cbranch_scc1 fl_124
fe_125:
    s_mov_b32 s30, s41
    v_mov_b32 v4, v22
    v_mov_b32 v5, v23
    s_cmp_eq_u32 s30, 0
    s_cbranch_scc1 fe_127
    v_mov_b32 v10, 0xf1800000
    s_cmp_ge_u32 s3, 8
    s_cselect_b32 s33, 0, 0x7f000000
    v_mov_b32 v11, -2.0
    v_add_f32_e64 v10, s33, v10
    v_fma_f32 v48, v96, v11, v10
    v_min_f32_e64 v48, 0, v48
    v_fma_f32 v49, v97, v11, v10
    v_min_f32_e64 v49, 0, v49
    v_fma_f32 v50, v98, v11, v10
    v_min_f32_e64 v50, 0, v50
    v_fma_f32 v51, v99, v11, v10
    v_min_f32_e64 v51, 0, v51
    v_fma_f32 v52, v100, v11, v10
    v_min_f32_e64 v52, 0, v52
    v_fma_f32 v53, v101, v11, v10
    v_min_f32_e64 v53, 0, v53
    v_fma_f32 v54, v102, v11, v10
    v_min_f32_e64 v54, 0, v54
    v_fma_f32 v55, v103, v11, v10
    v_min_f32_e64 v55, 0, v55
    v_fma_f32 v56, v104, v11, v10
    v_min_f32_e64 v56, 0, v56
    v_fma_f32 v57, v105, v11, v10
    v_min_f32_e64 v57, 0, v57
    v_fma_f32 v58, v106, v11, v10
    v_min_f32_e64 v58, 0, v58
    v_fma_f32 v59, v107, v11, v10
    v_min_f32_e64 v59, 0, v59
    v_fma_f32 v60, v108, v11, v10
    v_min_f32_e64 v60, 0, v60
    v_fma_f32 v61, v109, v11, v10
    v_min_f32_e64 v61, 0, v61
    v_fma_f32 v62, v110, v11, v10
    v_min_f32_e64 v62, 0, v62
    v_fma_f32 v63, v111, v11, v10
    v_min_f32_e64 v63, 0, v63
fl_126:
    ds_read_b128 v[88:91], v4
    s_waitcnt lgkmcnt(0)
    v_mfma_f32_32x32x16_bf16 v[32:47], v[88:91], v[16:19], v[48:63]
    v_add_u32 v4, 4096, v4
    v_add_u32 v5, 4096, v5
    s_nop 9
    v_max3_f32 v15, v32, v33, v15
    v_max3_f32 v15, v34, v35, v15
    v_max3_f32 v15, v36, v37, v15
    v_max3_f32 v15, v38, v39, v15
    v_max3_f32 v15, v40, v41, v15
    v_max3_f32 v15, v42, v43, v15
    v_max3_f32 v15, v44, v45, v15
    v_max3_f32 v15, v46, v47, v15
    v_mov_b32 v48, 0
    v_mov_b32 v49, 0
    v_mov_b32 v50, 0
    v_mov_b32 v51, 0
    v_mov_b32 v52, 0
    v_mov_b32 v53, 0
    v_mov_b32 v54, 0
    v_mov_b32 v55, 0
    v_mov_b32 v56, 0
    v_mov_b32 v57, 0
    v_mov_b32 v58, 0
    v_mov_b32 v59, 0
    v_mov_b32 v60, 0
    v_mov_b32 v61, 0
    v_mov_b32 v62, 0
    v_mov_b32 v63, 0
    s_sub_u32 s30, s30, 1
    s_cmp_lg_u32 s30, 0
    s_cbranch_scc1 fl_126
fe_127:
    v_mov_b32 v11, v15
    s_nop 1
    v_permlane32_swap_b32 v15, v11
    v_max_f32 v15, v15, v11
    s_add_u32 s30, s63, 1
    v_add_u32 v4, 24576, v20
    v_add_u32 v5, 24576, v21
    v_mov_b32 v48, v96
    v_mov_b32 v49, v97
    v_mov_b32 v50, v98
    v_mov_b32 v51, v99
    v_mov_b32 v52, v100
    v_mov_b32 v53, v101
    v_mov_b32 v54, v102
    v_mov_b32 v55, v103
    v_mov_b32 v56, v104
    v_mov_b32 v57, v105
    v_mov_b32 v58, v106
    v_mov_b32 v59, v107
    v_mov_b32 v60, v108
    v_mov_b32 v61, v109
    v_mov_b32 v62, v110
    v_mov_b32 v63, v111
fl_128:
    ds_read_b128 v[88:91], v4
    s_mov_b64 exec, s[38:39]
    ds_read_b128 v[72:75], v5 offset:0
    ds_read_b128 v[76:79], v5 offset:1024
    s_mov_b64 exec, -1
    s_waitcnt lgkmcnt(0)
    v_mfma_f32_32x32x16_bf16 v[32:47], v[88:91], v[16:19], v[48:63]
    v_add_u32 v4, 4294959104, v4
    v_add_u32 v5, 4294959104, v5
    s_nop 9
    v_sub_f32 v32, v32, v15
    v_sub_f32 v33, v33, v15
    v_sub_f32 v34, v34, v15
    v_sub_f32 v35, v35, v15
    v_sub_f32 v36, v36, v15
    v_sub_f32 v37, v37, v15
    v_sub_f32 v38, v38, v15
    v_sub_f32 v39, v39, v15
    v_sub_f32 v40, v40, v15
    v_sub_f32 v41, v41, v15
    v_sub_f32 v42, v42, v15
    v_sub_f32 v43, v43, v15
    v_sub_f32 v44, v44, v15
    v_sub_f32 v45, v45, v15
    v_sub_f32 v46, v46, v15
    v_sub_f32 v47, v47, v15
    v_exp_f32 v32, v32
    v_exp_f32 v33, v33
    v_exp_f32 v34, v34
    v_exp_f32 v35, v35
    v_exp_f32 v36, v36
    v_exp_f32 v37, v37
    v_exp_f32 v38, v38
    v_exp_f32 v39, v39
    v_exp_f32 v40, v40
    v_exp_f32 v41, v41
    v_exp_f32 v42, v42
    v_exp_f32 v43, v43
    v_exp_f32 v44, v44
    v_exp_f32 v45, v45
    v_exp_f32 v46, v46
    v_exp_f32 v47, v47
    v_cvt_pk_bf16_f32 v64, v32, v33
    v_cvt_pk_bf16_f32 v65, v34, v35
    v_cvt_pk_bf16_f32 v66, v36, v37
    v_cvt_pk_bf16_f32 v67, v38, v39
    v_cvt_pk_bf16_f32 v68, v40, v41
    v_cvt_pk_bf16_f32 v69, v42, v43
    v_cvt_pk_bf16_f32 v70, v44, v45
    v_cvt_pk_bf16_f32 v71, v46, v47
    v_mfma_f32_32x32x16_bf16 v[112:127], v[72:75], v[64:67], v[112:127]
    s_nop 0
    v_mfma_f32_32x32x16_bf16 v[112:127], v[76:79], v[68:71], v[112:127]
    v_mov_b32 v48, 0
    v_mov_b32 v49, 0
    v_mov_b32 v50, 0
    v_mov_b32 v51, 0
    v_mov_b32 v52, 0
    v_mov_b32 v53, 0
    v_mov_b32 v54, 0
    v_mov_b32 v55, 0
    v_mov_b32 v56, 0
    v_mov_b32 v57, 0
    v_mov_b32 v58, 0
    v_mov_b32 v59, 0
    v_mov_b32 v60, 0
    v_mov_b32 v61, 0
    v_mov_b32 v62, 0
    v_mov_b32 v63, 0
    s_sub_u32 s30, s30, 1
    s_cmp_lg_u32 s30, 0
    s_cbranch_scc1 fl_128
fe_129:
    s_mov_b32 s30, s41
    v_mov_b32 v4, v22
    v_mov_b32_e64 v5, v23
    s_cmp_eq_u32 s30, 0
    s_cbranch_scc1 fe_131
    v_mov_b32 v10, 0xf1800000
    s_cmp_ge_u32 s3, 8
    s_cselect_b32 s33, 0, 0x7f000000
    v_mov_b32 v11, -2.0
    v_add_f32_e64 v10, s33, v10
    v_fma_f32 v48, v96, v11, v10
    v_min_f32_e64 v48, 0, v48
    v_fma_f32 v49, v97, v11, v10
    v_min_f32_e64 v49, 0, v49
    v_fma_f32 v50, v98, v11, v10
    v_min_f32_e64 v50, 0, v50
    v_fma_f32 v51, v99, v11, v10
    v_min_f32_e64 v51, 0, v51
    v_fma_f32 v52, v100, v11, v10
    v_min_f32_e64 v52, 0, v52
    v_fma_f32 v53, v101, v11, v10
    v_min_f32_e64 v53, 0, v53
    v_fma_f32 v54, v102, v11, v10
    v_min_f32_e64 v54, 0, v54
    v_fma_f32 v55, v103, v11, v10
    v_min_f32_e64 v55, 0, v55
    v_fma_f32 v56, v104, v11, v10
    v_min_f32_e64 v56, 0, v56
    v_fma_f32 v57, v105, v11, v10
    v_min_f32_e64 v57, 0, v57
    v_fma_f32 v58, v106, v11, v10
    v_min_f32_e64 v58, 0, v58
    v_fma_f32 v59, v107, v11, v10
    v_min_f32_e64 v59, 0, v59
    v_fma_f32 v60, v108, v11, v10
    v_min_f32_e64 v60, 0, v60
    v_fma_f32 v61, v109, v11, v10
    v_min_f32_e64 v61, 0, v61
    v_fma_f32 v62, v110, v11, v10
    v_min_f32_e64 v62, 0, v62
    v_fma_f32 v63, v111, v11, v10
    v_min_f32_e64 v63, 0, v63
fl_130:
    ds_read_b128 v[88:91], v4
    s_mov_b64 exec, s[38:39]
    ds_read_b128 v[72:75], v5 offset:0
    ds_read_b128 v[76:79], v5 offset:1024
    s_mov_b64 exec, -1
    s_waitcnt lgkmcnt(0)
    v_mfma_f32_32x32x16_bf16 v[32:47], v[88:91], v[16:19], v[48:63]
    v_add_u32 v4, 4096, v4
    v_add_u32 v5, 4096, v5
    s_nop 9
    v_sub_f32 v32, v32, v15
    v_sub_f32 v33, v33, v15
    v_sub_f32 v34, v34, v15
    v_sub_f32 v35, v35, v15
    v_sub_f32 v36, v36, v15
    v_sub_f32 v37, v37, v15
    v_sub_f32 v38, v38, v15
    v_sub_f32 v39, v39, v15
    v_sub_f32 v40, v40, v15
    v_sub_f32 v41, v41, v15
    v_sub_f32 v42, v42, v15
    v_sub_f32 v43, v43, v15
    v_sub_f32 v44, v44, v15
    v_sub_f32 v45, v45, v15
    v_sub_f32 v46, v46, v15
    v_sub_f32 v47, v47, v15
    v_exp_f32 v32, v32
    v_exp_f32 v33, v33
    v_exp_f32 v34, v34
    v_exp_f32 v35, v35
    v_exp_f32 v36, v36
    v_exp_f32 v37, v37
    v_exp_f32 v38, v38
    v_exp_f32 v39, v39
    v_exp_f32 v40, v40
    v_exp_f32 v41, v41
    v_exp_f32 v42, v42
    v_exp_f32 v43, v43
    v_exp_f32 v44, v44
    v_exp_f32 v45, v45
    v_exp_f32 v46, v46
    v_exp_f32 v47, v47
    v_cvt_pk_bf16_f32 v64, v32, v33
    v_cvt_pk_bf16_f32 v65, v34, v35
    v_cvt_pk_bf16_f32 v66, v36, v37
    v_cvt_pk_bf16_f32 v67, v38, v39
    v_cvt_pk_bf16_f32 v68, v40, v41
    v_cvt_pk_bf16_f32 v69, v42, v43
    v_cvt_pk_bf16_f32 v70, v44, v45
    v_cvt_pk_bf16_f32 v71, v46, v47
    v_mfma_f32_32x32x16_bf16 v[112:127], v[72:75], v[64:67], v[112:127]
    s_nop 0
    v_mfma_f32_32x32x16_bf16 v[112:127], v[76:79], v[68:71], v[112:127]
    v_mov_b32 v48, 0
    v_mov_b32 v49, 0
    v_mov_b32 v50, 0
    v_mov_b32 v51, 0
    v_mov_b32 v52, 0
    v_mov_b32 v53, 0
    v_mov_b32 v54, 0
    v_mov_b32 v55, 0
    v_mov_b32 v56, 0
    v_mov_b32 v57, 0
    v_mov_b32 v58, 0
    v_mov_b32 v59, 0
    v_mov_b32 v60, 0
    v_mov_b32 v61, 0
    v_mov_b32 v62, 0
    v_mov_b32 v63, 0
    s_sub_u32 s30, s30, 1
    s_cmp_lg_u32 s30, 0
    s_cbranch_scc1 fl_130
fe_131:
    v_rcp_f32 v10, v120
    s_nop 0
    v_mov_b32_e64 v11, v10
    v_pk_mul_f32 v[112:113], v[112:113], v[10:11]
    v_pk_mul_f32 v[114:115], v[114:115], v[10:11]
    v_pk_mul_f32 v[116:117], v[116:117], v[10:11]
    v_pk_mul_f32 v[118:119], v[118:119], v[10:11]
    s_branch afin_93
fin_1:
    s_or_b32 s32, s2, s24
    s_cmp_lg_u32 s32, 0
    s_cbranch_scc1 nep_132
    v_mov_b32 v4, s36
    v_mov_b32 v5, 0
    s_mov_b32 s33, 33947648
    buffer_store_dword v4, v5, s[8:11], s33 offen sc1
nep_132:
interleave_layers__spectral_gfnet__sliding_block__prompt_kernel_end:
    s_endpgm
.section .rodata,"a"
.p2align 6
.amdhsa_kernel interleave_layers__spectral_gfnet__sliding_block__prompt_kernel
  .amdhsa_next_free_vgpr 256
  .amdhsa_next_free_sgpr 64
  .amdhsa_accum_offset 256
  .amdhsa_group_segment_fixed_size 0
  .amdhsa_kernarg_size 72
  .amdhsa_user_sgpr_count 2
  .amdhsa_user_sgpr_kernarg_segment_ptr 1
  .amdhsa_system_sgpr_workgroup_id_x 1
.end_amdhsa_kernel
```
